```python
import torch

def _softmax(x, axis=-1):
    return torch.softmax(x, dim=axis)
def _gelu(x):
    return torch.nn.functional.gelu(x, approximate="tanh")
def _silu(x):
    return torch.nn.functional.silu(x)
def _sigmoid(x):
    return torch.sigmoid(x)
def _layernorm(x, axis=-1, eps=1e-5):
    m = x.mean(dim=axis, keepdim=True)
    v = x.var(dim=axis, keepdim=True, unbiased=False)
    return (x - m) / torch.sqrt(v + eps)
def _scatter_add(tgt, idx, src, axis=0):
    return tgt.clone().index_add_(axis, idx, src)
def _segment_sum(src, seg, n):
    out = torch.zeros((n,) + src.shape[1:], dtype=src.dtype)
    return out.index_add_(0, seg, src)
def _pad(x, pw):
    flat = tuple(v for pair in reversed(pw) for v in pair)
    return torch.nn.functional.pad(x, flat)

kernel_name = 'standalone__window_attn_swin__vision'

def setup_inputs():

    _w = (lambda a: (lambda t: t.to(torch.bfloat16) if t.is_floating_point() else t)(torch.as_tensor(a)))
    H = W = 224
    C = 96
    ws = 7
    nh = 4
    shift = ws // 2
    coords = torch.stack(torch.meshgrid(torch.arange(ws), torch.arange(ws), indexing='ij'), 0).reshape(2, -1)
    rel = coords[:, :, None] - coords[:, None, :]
    rel[0] += ws - 1
    rel[1] += ws - 1
    rel[0] *= 2 * ws - 1
    rp_idx = rel.sum(0).to(torch.int64)
    img_mask = torch.zeros((1, H, W, 1), dtype=float)
    cnt = 0
    for hs in (slice(0, H - ws), slice(H - ws, H - shift), slice(H - shift, H)):
        for vs in (slice(0, W - ws), slice(W - ws, W - shift), slice(W - shift, W)):
            img_mask[:, hs, vs, :] = cnt
            cnt += 1
    mw = img_mask.reshape(1, H // ws, ws, W // ws, ws, 1).permute(0, 1, 3, 2, 4, 5).reshape(-1, ws * ws)
    am = mw[:, :, None] - mw[:, None, :]
    attn_mask = torch.where(am != 0, -100.0, 0.0).to(float)
    return {
        "x": _w((lambda *s: torch.randn(*s, dtype=torch.bfloat16) * 1.6)(1, H, W, C)),
        "wqkv": _w((lambda *s: torch.randn(*s, dtype=torch.bfloat16) * 1.6)(C, 3 * C) * 0.02),
        "wo": _w((lambda *s: torch.randn(*s, dtype=torch.bfloat16) * 0.05)(C, C) * 0.02),
        "rpb": _w((lambda *s: torch.randn(*s, dtype=torch.bfloat16) * 0.4)((2 * ws - 1) * (2 * ws - 1), nh)),
        "rp_idx": _w(rp_idx),
        "attn_mask": _w(attn_mask),
    }

def reference(x, wqkv, wo, rpb, rp_idx, attn_mask):
    B, H, W, C = x.shape
    N = rp_idx.shape[0]
    ws = int(round(N ** 0.5))
    nh = rpb.shape[-1]
    hd = C // nh
    shift = ws // 2
    xs = torch.roll(x, (-shift, -shift), (1, 2))
    nWh = H // ws
    nWw = W // ws
    xw = (lambda x, *d: x.permute(*d))(xs.reshape(B, nWh, ws, nWw, ws, C), 0, 1, 3, 2, 4, 5).reshape(B * nWh * nWw, N, C)
    qkv = (lambda x, *d: x.permute(*d))(torch.einsum('wnc,cd->wnd', xw, wqkv).reshape(-1, N, 3, nh, hd), 2, 0, 3, 1, 4)
    q, k, v = qkv[0], qkv[1], qkv[2]
    attn = torch.einsum('whid,whjd->whij', q, k) * (hd ** -0.5)
    bias = (lambda x, *d: x.permute(*d))(rpb[rp_idx.reshape(-1)].reshape(N, N, nh), 2, 0, 1)
    attn = attn + bias[None, :, :, :]
    attn = (attn.reshape(B, nWh * nWw, nh, N, N) + attn_mask[None, :, None, :, :]).reshape(-1, nh, N, N)
    attn = _softmax(attn, axis=-1)
    out = (lambda x, *d: x.permute(*d))(torch.einsum('whij,whjd->whid', attn, v), 0, 2, 1, 3).reshape(-1, N, C)
    out = torch.einsum('wnc,cd->wnd', out, wo)
    out = (lambda x, *d: x.permute(*d))(out.reshape(B, nWh, nWw, ws, ws, C), 0, 1, 3, 2, 4, 5).reshape(B, H, W, C)
    return torch.roll(out, (shift, shift), (1, 2))
```

```asm
; @launch grid=(256,1,1) block=(512,1,1) lds=150080
.amdgcn_target "amdgcn-amd-amdhsa--gfx950"
.text
.globl standalone__window_attn_swin__vision_kernel
.p2align 8
.type standalone__window_attn_swin__vision_kernel,@function
standalone__window_attn_swin__vision_kernel:
    s_cmp_ge_u32 s2, 256
    s_cbranch_scc1 L_end
    s_load_dwordx2 s[20:21], s[0:1], 0
    s_load_dwordx2 s[64:65], s[0:1], 8
    s_load_dwordx2 s[32:33], s[0:1], 24
    s_load_dwordx2 s[40:41], s[0:1], 16
    s_load_dwordx2 s[44:45], s[0:1], 48
    v_lshrrev_b32 v229, 6, v0
    v_and_b32 v226, 63, v0
    v_lshlrev_b32 v233, 4, v229
    v_mov_b32 v234, 0
    v_readfirstlane_b32 s3, v229
    ds_write_b32 v233, v234
    v_lshlrev_b32 v230, 4, v226
    v_mov_b32 v229, 43008
    s_mov_b32 s22, 9633792
    s_mov_b32 s23, 0x00020000
    s_mov_b32 s66, 55296
    s_mov_b32 s67, 0x00020000
    s_mov_b32 s34, 1352
    s_mov_b32 s35, 0x00020000
    s_mov_b32 s42, 18432
    s_mov_b32 s43, 0x00020000
    s_mov_b32 s46, 9633792
    s_mov_b32 s47, 0x00020000
    s_and_b32 s48, s3, 1
    s_lshr_b32 s50, s3, 2
    s_lshr_b32 s56, s3, 1
    s_and_b32 s49, s56, 1
    s_lshl_b32 s51, s2, 2
    s_add_u32 s51, s51, s56
    s_mul_i32 s72, s56, 6144
    s_add_u32 s72, s72, 125504
    s_mul_i32 s38, s49, 9520
    s_cmp_eq_u32 s50, 0
    s_mov_b32 s57, 87424
    s_cselect_b32 s57, 106464, s57
    s_add_u32 s38, s38, s57
    s_lshr_b32 s58, s51, 5
    s_and_b32 s59, s51, 31
    s_cmp_eq_u32 s58, 31
    s_cselect_b32 s54, 4, 64
    s_cmp_eq_u32 s59, 31
    s_cselect_b32 s55, 4, 64
    s_mul_i32 s52, s58, 7
    s_add_u32 s52, s52, 3
    s_mul_i32 s53, s59, 7
    s_add_u32 s53, s53, 3
    s_mul_i32 s73, s52, 224
    s_add_u32 s73, s73, s53
    s_mul_i32 s73, s73, 192
    s_mul_i32 s56, s48, 44
    s_mul_i32 s57, s55, 12
    s_sub_u32 s57, s57, s56
    s_mul_i32 s56, s48, 704
    v_cmp_le_u32 s[74:75], s57, v226
    v_add_u32 v231, s56, v230
    v_and_b32 v227, 31, v226
    v_cndmask_b32_e64 v229, 0, v229, s[74:75]
    v_sub_u32 v231, v231, v229
    v_lshrrev_b32 v228, 5, v226
    s_add_u32 s39, s56, s38
    s_lshl_b32 s62, s3, 4
    s_xor_b32 s57, s3, 1
    s_lshl_b32 s63, 1, s57
    v_add_u32 v56, s73, v231
    s_add_u32 s73, s73, 43008
    s_cmp_ge_u32 s73, 9633792
    s_cselect_b32 s57, 9633792, 0
    s_sub_u32 s73, s73, s57
    v_add_u32 v57, s73, v231
    s_add_u32 s73, s73, 43008
    s_cmp_ge_u32 s73, 9633792
    s_cselect_b32 s57, 9633792, 0
    s_sub_u32 s73, s73, s57
    v_add_u32 v58, s73, v231
    s_add_u32 s73, s73, 43008
    s_cmp_ge_u32 s73, 9633792
    s_cselect_b32 s57, 9633792, 0
    s_sub_u32 s73, s73, s57
    v_add_u32 v59, s73, v231
    s_add_u32 s73, s73, 43008
    s_cmp_ge_u32 s73, 9633792
    s_cselect_b32 s57, 9633792, 0
    s_sub_u32 s73, s73, s57
    v_add_u32 v60, s73, v231
    s_add_u32 s73, s73, 43008
    s_cmp_ge_u32 s73, 9633792
    s_cselect_b32 s57, 9633792, 0
    s_sub_u32 s73, s73, s57
    v_add_u32 v61, s73, v231
    s_add_u32 s73, s73, 43008
    s_cmp_ge_u32 s73, 9633792
    s_cselect_b32 s57, 9633792, 0
    s_sub_u32 s73, s73, s57
    v_add_u32 v62, s73, v231
    v_mul_u32_u24 v233, 0xab, v226
    v_lshrrev_b32 v233, 12, v233
    v_mul_u32_u24 v233, 0xc0, v233
    v_lshl_add_u32 v235, v226, 4, v233
    s_mov_b32 exec_lo, 0x0
    s_mov_b32 exec_hi, 0xf0f0000
    v_add_u32 v235, 0xc0, v235
    s_mov_b32 exec_lo, 0x0
    s_mov_b32 exec_hi, 0xf0000000
    v_subrev_u32 v235, 0xc0, v235
    s_mov_b32 exec_lo, 0x0
    s_mov_b32 exec_hi, 0xf00000
    v_xor_b32 v235, 32, v235
    s_mov_b64 exec, -1
    v_add_u32 v229, 64, v226
    v_mul_u32_u24 v233, 0xab, v229
    v_lshrrev_b32 v233, 12, v233
    v_mul_u32_u24 v233, 0xc0, v233
    v_lshl_add_u32 v236, v229, 4, v233
    s_mov_b32 exec_lo, 0xf0f00
    s_mov_b32 exec_hi, 0x0
    v_add_u32 v236, 0xc0, v236
    s_mov_b32 exec_lo, 0xf0f000f0
    s_mov_b32 exec_hi, 0x0
    v_subrev_u32 v236, 0xc0, v236
    s_mov_b32 exec_lo, 0xf00f00f
    s_mov_b32 exec_hi, 0x0
    v_xor_b32 v236, 32, v236
    s_mov_b64 exec, -1
    v_mov_b32 v239, s62
    s_cmp_eq_u32 s50, 0
    s_cbranch_scc0 L_pb
    s_waitcnt lgkmcnt(0)
    s_cmp_eq_u32 s48, 0
    s_movk_i32 exec_hi, 0xff
    s_cselect_b32 exec_hi, 0xfff, exec_hi
    s_mov_b32 m0, s39
    s_nop 0
    buffer_load_dwordx4 v56, s[20:23], 0 offen nt lds
    s_add_u32 m0, s39, 1360
    s_nop 0
    buffer_load_dwordx4 v57, s[20:23], 0 offen nt lds
    s_add_u32 m0, s39, 2720
    s_nop 0
    buffer_load_dwordx4 v58, s[20:23], 0 offen nt lds
    s_add_u32 m0, s39, 4080
    s_nop 0
    buffer_load_dwordx4 v59, s[20:23], 0 offen nt lds
    s_add_u32 m0, s39, 5440
    s_nop 0
    buffer_load_dwordx4 v60, s[20:23], 0 offen nt lds
    s_add_u32 m0, s39, 6800
    s_nop 0
    buffer_load_dwordx4 v61, s[20:23], 0 offen nt lds
    s_add_u32 m0, s39, 8160
    s_nop 0
    buffer_load_dwordx4 v62, s[20:23], 0 offen nt lds
    s_mov_b64 exec, -1
    s_mul_i32 s58, s3, 4608
    s_mul_i32 s59, s3, 3072
    s_add_u32 m0, s59, 128
    s_nop 0
    buffer_load_dwordx4 v235, s[64:67], s58 offen lds
    s_add_u32 m0, s59, 1152
    s_nop 0
    buffer_load_dwordx4 v236, s[64:67], s58 offen lds
    v_add_u32 v229, 128, v226
    v_mul_u32_u24 v233, 0xab, v229
    v_lshrrev_b32 v233, 12, v233
    v_mul_u32_u24 v233, 0xc0, v233
    v_lshl_add_u32 v237, v229, 4, v233
    s_mov_b32 exec_lo, 0xf0f0000
    s_mov_b32 exec_hi, 0xf0f00
    v_add_u32 v237, 0xc0, v237
    s_mov_b32 exec_lo, 0xf0000000
    s_mov_b32 exec_hi, 0xf0f000f0
    v_subrev_u32 v237, 0xc0, v237
    s_mov_b32 exec_lo, 0xf00000
    s_mov_b32 exec_hi, 0xf00f00f
    v_xor_b32 v237, 32, v237
    s_mov_b64 exec, -1
    s_add_u32 m0, s59, 2176
    s_nop 0
    buffer_load_dwordx4 v237, s[64:67], s58 offen lds
    s_barrier
    v_bfe_u32 v240, v226, 2, 2
    v_and_b32 v241, 3, v226
    v_bfe_u32 v242, v226, 4, 1
    v_bfe_u32 v252, v226, 2, 3
    v_and_b32 v254, 3, v226
    v_add_u32 v253, 2, v252
    v_or_b32 v255, 4, v241
    s_mov_b32 exec_lo, 0xff000000
    s_mov_b32 exec_hi, 0xff000000
    v_subrev_u32 v252, 6, v252
    v_or_b32 v254, 4, v254
    s_mov_b32 exec_lo, 0x88000000
    s_mov_b32 exec_hi, 0x88000000
    v_mov_b32 v254, v252
    v_mov_b32 v252, 6
    s_mov_b32 exec_lo, 0xffff8888
    s_mov_b32 exec_hi, 0xffff8888
    v_min_u32 v255, 6, v253
    v_mov_b32 v253, 6
    s_mov_b64 exec, -1
    v_lshl_add_u32 v246, v228, 3, v240
    v_mul_u32_u24 v243, 0x180, v246
    v_lshl_add_u32 v243, v241, 3, v243
    v_bfe_u32 v244, v226, 3, 1
    v_mul_u32_u24 v245, 0xc0, v244
    v_lshl_add_u32 v247, v242, 5, v243
    v_add_u32 v1, v247, v245
    v_sub_u32 v2, v247, v245
    v_xor_b32 v244, s48, v244
    v_lshl_add_u32 v243, v244, 5, v243
    v_mul_u32_u24 v245, 0xc0, v242
    v_add_u32 v111, v243, v245
    v_lshlrev_b32 v251, 4, v228
    v_add_u32 v247, s38, v251
    v_mul_u32_u24 v248, 0xc0, v254
    v_mul_u32_u24 v244, 0x550, v252
    v_add3_u32 v224, v248, v244, v247
    v_mul_u32_u24 v248, 0xc0, v255
    v_mul_u32_u24 v244, 0x550, v253
    v_add3_u32 v225, v248, v244, v247
    v_and_b32 v141, 0x70, v230
    v_mov_b64 v[32:33], 0
    v_mov_b64 v[34:35], 0
    v_mov_b64 v[36:37], 0
    v_mov_b64 v[38:39], 0
    v_mov_b64 v[40:41], 0
    v_mov_b64 v[42:43], 0
    v_mov_b64 v[44:45], 0
    v_mov_b64 v[46:47], 0
    v_mov_b64 v[48:49], 0
    v_mov_b64 v[50:51], 0
    v_mov_b64 v[52:53], 0
    v_mov_b64 v[54:55], 0
    s_mov_b32 s36, 0x1ffff
    s_mov_b32 s37, 0x1ffff
    v_mul_u32_u24 v243, 0xc0, v246
    v_lshl_add_u32 v243, v241, 3, v243
    v_lshl_add_u32 v243, v242, 5, v243
    v_add_u32 v7, 36992, v243
    v_lshl_add_u32 v243, v228, 2, v240
    v_mul_u32_u24 v243, 0xc0, v243
    v_lshl_add_u32 v243, v242, 5, v243
    v_and_b32 v240, 1, v241
    v_lshrrev_b32 v241, 1, v241
    v_lshl_add_u32 v240, v240, 1, v241
    v_lshl_add_u32 v243, v240, 3, v243
    v_add_u32 v3, 55424, v243
    s_mov_b32 s4, 0x3e96c740
    s_mov_b32 s5, 0x0d800000
    s_mov_b32 s11, 0x63ffffff
    s_lshl_b32 s6, 1, s3
    s_mov_b32 s7, 0
    s_and_b32 s24, s6, 15
    s_mov_b32 s25, 0
    s_and_b32 s28, s3, 3
    s_mul_i32 s26, s28, 13824
    s_add_u32 s26, s26, 384
    s_mul_i32 s27, s28, 4608
    s_lshl_b32 s28, s28, 10
    v_mov_b32 v127, 4
    s_mov_b32 s71, 0x3f80
    s_add_u32 s59, s55, s54
    s_cmp_eq_u32 s59, 128
    s_cselect_b32 s59, 0, 0xc310
    s_cselect_b32 s58, 0, 0xbe8a
    v_mov_b32 v250, s59
    s_mov_b32 exec_lo, 0x0
    s_mov_b32 exec_hi, 0xffffffff
    v_mov_b32 v250, s58
    s_mov_b64 exec, -1
    v_lshl_or_b32 v249, v250, 16, v250
    s_mul_i32 s59, s48, 6784
    s_add_u32 s59, s59, 73856
    v_cmp_le_u32 s[76:77], s55, v254
    v_cmp_le_u32 s[78:79], s54, v252
    v_sub_u32 v240, 6, v254
    v_and_b32 v241, 3, v240
    v_add_lshl_u32 v240, v240, 3, 2
    v_and_b32 v240, 0xfff0, v240
    v_mul_u32_u24 v241, 0x350, v241
    v_add3_u32 v240, v240, v241, s59
    v_sub_u32 v241, 6, v252
    v_lshl_add_u32 v143, v241, 6, v240
    v_lshl_add_u32 v4, v228, 6, v143
    v_lshl_add_u32 v6, v228, 2, v143
    v_cndmask_b32_e64 v247, 0, 16, s[76:77]
    v_lshlrev_b32_e64 v248, v247, s71
    v_cndmask_b32_e64 v78, v248, 0, s[78:79]
    v_cndmask_b32_e64 v79, 0, v248, s[78:79]
    v_lshlrev_b32 v248, v247, v250
    v_xor_b32 v248, v248, v249
    v_cndmask_b32_e64 v106, v248, v249, s[78:79]
    v_cndmask_b32_e64 v107, v249, v248, s[78:79]
    v_cmp_le_u32 s[76:77], s55, v255
    v_cmp_le_u32 s[78:79], s54, v253
    v_sub_u32 v240, 6, v255
    v_and_b32 v241, 3, v240
    v_add_lshl_u32 v240, v240, 3, 2
    v_and_b32 v240, 0xfff0, v240
    v_mul_u32_u24 v241, 0x350, v241
    v_add3_u32 v240, v240, v241, s59
    v_sub_u32 v241, 6, v253
    v_lshl_add_u32 v159, v241, 6, v240
    v_lshl_add_u32 v5, v228, 6, v159
    v_lshl_add_u32 v142, v228, 2, v159
    v_cndmask_b32_e64 v247, 0, 16, s[76:77]
    v_lshlrev_b32_e64 v248, v247, s71
    v_cndmask_b32_e64 v92, v248, 0, s[78:79]
    v_cndmask_b32_e64 v93, 0, v248, s[78:79]
    v_lshlrev_b32 v248, v247, v250
    v_xor_b32 v248, v248, v249
    v_cndmask_b32_e64 v120, v248, v249, s[78:79]
    v_cndmask_b32_e64 v121, v249, v248, s[78:79]
    s_add_u32 s59, s59, 4294966940
    s_mov_b32 exec_lo, 0x0
    s_mov_b32 exec_hi, 0xffffffff
    v_mov_b32 v143, s59
    v_mov_b32 v159, s59
    s_mov_b64 exec, -1
    s_cmp_eq_u32 s48, 0
    s_cselect_b64 s[76:77], 0, -1
    s_cselect_b64 s[74:75], -1, s[36:37]
    v_cndmask_b32_e64 v244, v252, v253, s[76:77]
    v_cndmask_b32_e64 v245, v254, v255, s[76:77]
    v_add_u32 v246, s52, v244
    v_subrev_u32 v247, 224, v246
    v_min_u32 v246, v246, v247
    v_add_u32 v248, s53, v245
    v_subrev_u32 v247, 224, v248
    v_min_u32 v248, v248, v247
    v_mul_u32_u24 v246, 0xe0, v246
    v_add_u32 v246, v246, v248
    v_mul_u32_u24 v246, 0xc0, v246
    v_add_u32 v246, v246, v251
    v_mov_b32 v241, 0x40000000
    v_cndmask_b32_e64 v0, v241, v246, s[74:75]
    s_mov_b32 s60, 0x00ffffff
    s_mov_b32 s61, 0x00ffffff
    s_mov_b32 s68, 0x3f803f80
    s_mov_b32 s69, 0x3f803f80
    v_mov_b64 v[240:241], 0
    s_mov_b32 exec_lo, 0x11000000
    s_mov_b32 exec_hi, 0x11000000
    v_mov_b64 v[240:241], s[68:69]
    s_mov_b64 exec, -1
    v_mov_b64 v[128:129], v[240:241]
    v_mov_b64 v[130:131], v[240:241]
    v_mov_b64 v[132:133], v[240:241]
    v_mov_b64 v[134:135], v[240:241]
    v_mov_b64 v[136:137], v[240:241]
    v_mov_b64 v[138:139], v[240:241]
    v_mov_b32 v140, v240
    v_mov_b64 v[144:145], v[240:241]
    v_mov_b64 v[146:147], v[240:241]
    v_mov_b64 v[148:149], v[240:241]
    v_mov_b64 v[150:151], v[240:241]
    v_mov_b64 v[152:153], v[240:241]
    v_mov_b64 v[154:155], v[240:241]
    v_mov_b32 v156, v240
    v_mov_b32 v240, 0x70006
    v_lshl_or_b32 v157, v226, 24, v240
    v_mul_u32_u24 v229, 43, v226
    v_lshrrev_b32 v229, 9, v229
    v_mul_u32_u24 v229, 0x180, v229
    v_add_u32 v72, v230, v229
    v_mov_b32 v73, v230
    s_mov_b64 exec, -1
L_tr:
    v_mov_b32 v233, 3
    v_mov_b32 v238, 0
    s_mov_b32 exec_lo, 0xf0f0f0f
    s_mov_b32 exec_hi, 0xf0f0f0f
    v_mov_b32 v238, 3
    s_mov_b64 exec, -1
    s_waitcnt vmcnt(0) lgkmcnt(0)
    ds_write_b32 v239, v233
    s_branch L_sa1
L_sa0:
    s_sleep 1
L_sa1:
    ds_read_b32 v233, v141
    s_waitcnt lgkmcnt(0)
    v_cmp_gt_u32 vcc, v238, v233
    s_nop 0
    s_cbranch_vccnz L_sa0
L_join:
    s_cmp_eq_u32 s48, 0
    s_cbranch_scc0 L_body1
    s_branch L_body0
L_pb:
    s_and_b32 s29, s3, 3
    s_mul_i32 s8, s29, 4608
    s_mul_i32 s9, s29, 3072
    s_cmp_eq_u32 s48, 0
    s_movk_i32 s13, 0xff
    s_cselect_b32 s13, 0xfff, s13
    v_add_u32 v229, 128, v226
    v_mul_u32_u24 v233, 0xab, v229
    v_lshrrev_b32 v233, 12, v233
    v_mul_u32_u24 v233, 0xc0, v233
    v_lshl_add_u32 v237, v229, 4, v233
    s_mov_b32 exec_lo, 0xf0f0000
    s_mov_b32 exec_hi, 0xf0f00
    v_add_u32 v237, 0xc0, v237
    s_mov_b32 exec_lo, 0xf0000000
    s_mov_b32 exec_hi, 0xf0f000f0
    v_subrev_u32 v237, 0xc0, v237
    s_mov_b32 exec_lo, 0xf00000
    s_mov_b32 exec_hi, 0xf00f00f
    v_xor_b32 v237, 32, v237
    s_mov_b64 exec, -1
    s_and_b32 s15, s3, 3
    v_lshlrev_b32 v163, 3, v226
    s_mul_i32 s16, s15, 3392
    s_add_u32 s56, s16, 73908
    s_add_u32 s16, s16, 74672
    s_and_b32 s17, s15, 1
    s_xor_b32 s17, s17, 1
    s_lshl_b32 s17, s17, 4
    v_mov_b32 v167, s56
    v_mov_b32 v168, 0xf149f2ca
    ds_write_b32 v167, v168
    v_mul_u32_u24 v164, 0x4f, v226
    v_lshrrev_b32 v164, 10, v164
    v_mad_u32_u24 v164, v164, 3, v226
    v_lshlrev_b32 v164, 2, v164
    v_sub_u32 v164, s16, v164
    v_add_u32 v169, 64, v226
    v_mul_u32_u24 v165, 0x4f, v169
    v_lshrrev_b32 v165, 10, v165
    v_mad_u32_u24 v165, v165, 3, v169
    v_lshlrev_b32 v165, 2, v165
    v_sub_u32 v165, s16, v165
    v_add_u32 v169, 128, v226
    v_mul_u32_u24 v166, 0x4f, v169
    v_lshrrev_b32 v166, 10, v166
    v_mad_u32_u24 v166, v166, 3, v169
    v_lshlrev_b32 v166, 2, v166
    v_sub_u32 v166, s16, v166
    s_setprio 3
    s_waitcnt lgkmcnt(0)
    s_lshr_b32 s56, s15, 1
    s_lshl_b32 s56, s56, 2
    buffer_load_dword v160, v163, s[32:35], s56 offen
    buffer_load_dword v161, v163, s[32:35], s56 offen offset:512
    buffer_load_dword v162, v163, s[32:35], s56 offen offset:1024
    s_barrier
    s_setprio 0
    v_bfe_u32 v240, v226, 2, 2
    s_add_u32 m0, s9, 12416
    s_add_u32 s29, s8, 18432
    buffer_load_dwordx4 v235, s[64:67], s29 offen lds
    v_and_b32 v241, 3, v226
    v_bfe_u32 v242, v226, 4, 1
    v_bfe_u32 v252, v226, 2, 3
    v_and_b32 v254, 3, v226
    v_add_u32 v253, 2, v252
    v_or_b32 v255, 4, v241
    s_add_u32 m0, s9, 13440
    s_add_u32 s29, s8, 18432
    buffer_load_dwordx4 v236, s[64:67], s29 offen lds
    s_mov_b32 exec_lo, 0xff000000
    s_mov_b32 exec_hi, 0xff000000
    v_subrev_u32 v252, 6, v252
    v_or_b32 v254, 4, v254
    s_mov_b32 exec_lo, 0x88000000
    s_mov_b32 exec_hi, 0x88000000
    v_mov_b32 v254, v252
    v_mov_b32 v252, 6
    s_mov_b32 exec_lo, 0xffff8888
    s_mov_b32 exec_hi, 0xffff8888
    v_min_u32 v255, 6, v253
    v_mov_b32 v253, 6
    s_mov_b64 exec, -1
    v_lshl_add_u32 v246, v228, 3, v240
    v_mul_u32_u24 v243, 0x180, v246
    v_lshl_add_u32 v243, v241, 3, v243
    v_bfe_u32 v244, v226, 3, 1
    v_mul_u32_u24 v245, 0xc0, v244
    v_lshl_add_u32 v247, v242, 5, v243
    s_add_u32 m0, s9, 14464
    s_add_u32 s29, s8, 18432
    buffer_load_dwordx4 v237, s[64:67], s29 offen lds
    v_add_u32 v1, v247, v245
    v_sub_u32 v2, v247, v245
    v_xor_b32 v244, s48, v244
    v_lshl_add_u32 v243, v244, 5, v243
    v_mul_u32_u24 v245, 0xc0, v242
    v_add_u32 v111, v243, v245
    s_add_u32 m0, s9, 24704
    s_add_u32 s29, s8, 36864
    buffer_load_dwordx4 v235, s[64:67], s29 offen lds
    v_lshlrev_b32 v251, 4, v228
    v_add_u32 v247, s38, v251
    v_mul_u32_u24 v248, 0xc0, v254
    v_mul_u32_u24 v244, 0x550, v252
    v_add3_u32 v224, v248, v244, v247
    v_mul_u32_u24 v248, 0xc0, v255
    s_add_u32 m0, s9, 25728
    s_add_u32 s29, s8, 36864
    buffer_load_dwordx4 v236, s[64:67], s29 offen lds
    v_mul_u32_u24 v244, 0x550, v253
    v_add3_u32 v225, v248, v244, v247
    v_and_b32 v141, 0x70, v230
    v_mov_b64 v[32:33], 0
    v_mov_b64 v[34:35], 0
    v_mov_b64 v[36:37], 0
    s_add_u32 m0, s9, 26752
    s_add_u32 s29, s8, 36864
    buffer_load_dwordx4 v237, s[64:67], s29 offen lds
    v_mov_b64 v[38:39], 0
    v_mov_b64 v[40:41], 0
    v_mov_b64 v[42:43], 0
    v_mov_b64 v[44:45], 0
    v_mov_b64 v[46:47], 0
    v_mov_b64 v[48:49], 0
    s_add_u32 m0, s39, 0
    s_mov_b32 exec_hi, s13
    buffer_load_dwordx4 v56, s[20:23], 0 offen nt lds
    s_mov_b32 exec_hi, -1
    v_mov_b64 v[50:51], 0
    v_mov_b64 v[52:53], 0
    v_mov_b64 v[54:55], 0
    s_mov_b32 s36, 0x1ffff
    s_mov_b32 s37, 0x1ffff
    v_mul_u32_u24 v243, 0xc0, v246
    v_lshl_add_u32 v243, v241, 3, v243
    v_lshl_add_u32 v243, v242, 5, v243
    s_add_u32 m0, s39, 1360
    s_mov_b32 exec_hi, s13
    buffer_load_dwordx4 v57, s[20:23], 0 offen nt lds
    s_mov_b32 exec_hi, -1
    v_add_u32 v7, 36992, v243
    v_lshl_add_u32 v243, v228, 2, v240
    v_mul_u32_u24 v243, 0xc0, v243
    v_lshl_add_u32 v243, v242, 5, v243
    v_and_b32 v240, 1, v241
    v_lshrrev_b32 v241, 1, v241
    s_add_u32 m0, s39, 2720
    s_mov_b32 exec_hi, s13
    buffer_load_dwordx4 v58, s[20:23], 0 offen nt lds
    s_mov_b32 exec_hi, -1
    v_lshl_add_u32 v240, v240, 1, v241
    v_lshl_add_u32 v243, v240, 3, v243
    v_add_u32 v3, 55424, v243
    s_mov_b32 s4, 0x3e96c740
    s_mov_b32 s5, 0x0d800000
    s_mov_b32 s11, 0x63ffffff
    s_lshl_b32 s6, 1, s3
    s_mov_b32 s7, 0
    s_and_b32 s24, s6, 15
    s_mov_b32 s25, 0
    s_and_b32 s28, s3, 3
    s_mul_i32 s26, s28, 13824
    s_add_u32 s26, s26, 384
    s_mul_i32 s27, s28, 4608
    s_lshl_b32 s28, s28, 10
    v_mov_b32 v127, 4
    s_mov_b32 s71, 0x3f80
    s_add_u32 s59, s55, s54
    s_cmp_eq_u32 s59, 128
    s_cselect_b32 s59, 0, 0xc310
    s_cselect_b32 s58, 0, 0xbe8a
    v_mov_b32 v250, s59
    s_mov_b32 exec_lo, 0x0
    s_mov_b32 exec_hi, 0xffffffff
    v_mov_b32 v250, s58
    s_mov_b64 exec, -1
    v_lshl_or_b32 v249, v250, 16, v250
    s_waitcnt vmcnt(9)
    v_lshlrev_b32 v160, s17, v160
    v_and_b32 v160, 0xffff0000, v160
    v_mul_f32 v160, 0x3fb8aa3b, v160
    ds_write_b32 v164, v160
    ds_write_b32 v164, v160 offset:860
    ds_write_b32 v164, v160 offset:1704
    ds_write_b32 v164, v160 offset:2548
    v_lshlrev_b32 v161, s17, v161
    v_and_b32 v161, 0xffff0000, v161
    v_mul_f32 v161, 0x3fb8aa3b, v161
    ds_write_b32 v165, v161
    ds_write_b32 v165, v161 offset:860
    ds_write_b32 v165, v161 offset:1704
    ds_write_b32 v165, v161 offset:2548
    v_lshlrev_b32 v162, s17, v162
    v_and_b32 v162, 0xffff0000, v162
    v_mul_f32 v162, 0x3fb8aa3b, v162
    s_mov_b32 exec_hi, 0x1ff
    ds_write_b32 v166, v162
    ds_write_b32 v166, v162 offset:860
    ds_write_b32 v166, v162 offset:1704
    ds_write_b32 v166, v162 offset:2548
    s_mov_b32 exec_hi, -1
    s_mul_i32 s59, s48, 6784
    s_add_u32 s59, s59, 73856
    v_cmp_le_u32 s[76:77], s55, v254
    v_cmp_le_u32 s[78:79], s54, v252
    v_sub_u32 v240, 6, v254
    v_and_b32 v241, 3, v240
    v_add_lshl_u32 v240, v240, 3, 2
    v_and_b32 v240, 0xfff0, v240
    v_mov_b32 v238, 2
    s_waitcnt vmcnt(6)
    ds_write_b32 v239, v238
    v_mul_u32_u24 v241, 0x350, v241
    v_add3_u32 v240, v240, v241, s59
    v_sub_u32 v241, 6, v252
    v_lshl_add_u32 v143, v241, 6, v240
    v_lshl_add_u32 v4, v228, 6, v143
    v_lshl_add_u32 v6, v228, 2, v143
    v_mov_b32 v238, 4
    s_waitcnt vmcnt(3)
    ds_write_b32 v239, v238
    v_cndmask_b32_e64 v247, 0, 16, s[76:77]
    v_lshlrev_b32_e64 v248, v247, s71
    v_cndmask_b32_e64 v78, v248, 0, s[78:79]
    v_cndmask_b32_e64 v79, 0, v248, s[78:79]
    v_lshlrev_b32 v248, v247, v250
    v_xor_b32 v248, v248, v249
    s_add_u32 m0, s39, 4080
    s_mov_b32 exec_hi, s13
    buffer_load_dwordx4 v59, s[20:23], 0 offen nt lds
    s_mov_b32 exec_hi, -1
    v_cndmask_b32_e64 v106, v248, v249, s[78:79]
    v_cndmask_b32_e64 v107, v249, v248, s[78:79]
    v_cmp_le_u32 s[76:77], s55, v255
    v_cmp_le_u32 s[78:79], s54, v253
    v_sub_u32 v240, 6, v255
    v_and_b32 v241, 3, v240
    s_add_u32 m0, s39, 5440
    s_mov_b32 exec_hi, s13
    buffer_load_dwordx4 v60, s[20:23], 0 offen nt lds
    s_mov_b32 exec_hi, -1
    v_add_lshl_u32 v240, v240, 3, 2
    v_and_b32 v240, 0xfff0, v240
    v_mul_u32_u24 v241, 0x350, v241
    v_add3_u32 v240, v240, v241, s59
    v_sub_u32 v241, 6, v253
    v_lshl_add_u32 v159, v241, 6, v240
    s_add_u32 m0, s39, 6800
    s_mov_b32 exec_hi, s13
    buffer_load_dwordx4 v61, s[20:23], 0 offen nt lds
    s_mov_b32 exec_hi, -1
    v_lshl_add_u32 v5, v228, 6, v159
    v_lshl_add_u32 v142, v228, 2, v159
    v_cndmask_b32_e64 v247, 0, 16, s[76:77]
    v_lshlrev_b32_e64 v248, v247, s71
    v_cndmask_b32_e64 v92, v248, 0, s[78:79]
    v_cndmask_b32_e64 v93, 0, v248, s[78:79]
    s_add_u32 m0, s39, 8160
    s_mov_b32 exec_hi, s13
    buffer_load_dwordx4 v62, s[20:23], 0 offen nt lds
    s_mov_b32 exec_hi, -1
    v_lshlrev_b32 v248, v247, v250
    v_xor_b32 v248, v248, v249
    v_cndmask_b32_e64 v120, v248, v249, s[78:79]
    v_cndmask_b32_e64 v121, v249, v248, s[78:79]
    s_add_u32 s59, s59, 4294966940
    s_mov_b32 exec_lo, 0x0
    s_mov_b32 exec_hi, 0xffffffff
    v_mov_b32 v143, s59
    v_mov_b32 v159, s59
    s_mov_b64 exec, -1
    s_cmp_eq_u32 s48, 0
    s_cselect_b64 s[76:77], 0, -1
    s_cselect_b64 s[74:75], -1, s[36:37]
    v_cndmask_b32_e64 v244, v252, v253, s[76:77]
    v_cndmask_b32_e64 v245, v254, v255, s[76:77]
    v_add_u32 v246, s52, v244
    v_subrev_u32 v247, 224, v246
    v_min_u32 v246, v246, v247
    v_add_u32 v248, s53, v245
    v_subrev_u32 v247, 224, v248
    v_min_u32 v248, v248, v247
    v_mul_u32_u24 v246, 0xe0, v246
    v_add_u32 v246, v246, v248
    v_mul_u32_u24 v246, 0xc0, v246
    v_add_u32 v246, v246, v251
    v_mov_b32 v241, 0x40000000
    v_cndmask_b32_e64 v0, v241, v246, s[74:75]
    s_mov_b32 s60, 0x00ffffff
    s_mov_b32 s61, 0x00ffffff
    s_mov_b32 s68, 0x3f803f80
    s_mov_b32 s69, 0x3f803f80
    v_mov_b64 v[240:241], 0
    s_mov_b32 exec_lo, 0x11000000
    s_mov_b32 exec_hi, 0x11000000
    v_mov_b64 v[240:241], s[68:69]
    s_mov_b64 exec, -1
    v_mov_b64 v[128:129], v[240:241]
    v_mov_b64 v[130:131], v[240:241]
    v_mov_b64 v[132:133], v[240:241]
    v_mov_b64 v[134:135], v[240:241]
    v_mov_b64 v[136:137], v[240:241]
    v_mov_b64 v[138:139], v[240:241]
    v_mov_b32 v140, v240
    v_mov_b64 v[144:145], v[240:241]
    v_mov_b64 v[146:147], v[240:241]
    v_mov_b64 v[148:149], v[240:241]
    v_mov_b64 v[150:151], v[240:241]
    v_mov_b64 v[152:153], v[240:241]
    v_mov_b64 v[154:155], v[240:241]
    v_mov_b32 v156, v240
    v_mov_b32 v240, 0x70006
    v_lshl_or_b32 v157, v226, 24, v240
    v_mov_b64 v[72:73], 0
    s_setprio 0
    v_mov_b32 v233, 6
    v_mov_b32 v238, 0
    s_mov_b32 exec_lo, 0xf0f0f0f
    s_mov_b32 exec_hi, 0xf0f0f0f
    v_mov_b32 v238, 3
    s_mov_b32 exec_lo, s63
    s_mov_b32 exec_hi, 0
    v_mov_b32 v238, 6
    s_mov_b64 exec, -1
    s_waitcnt vmcnt(0) lgkmcnt(0)
    ds_write_b32 v239, v233
    s_branch L_sb1
L_sb0:
    s_sleep 1
L_sb1:
    ds_read_b32 v233, v141
    s_waitcnt lgkmcnt(0)
    v_cmp_gt_u32 vcc, v238, v233
    s_nop 0
    s_cbranch_vccnz L_sb0
L_join2:
    s_cmp_eq_u32 s48, 0
    s_cbranch_scc0 L_body1
    s_branch L_body0
L_t0:
    s_branch L_tr
L_body0:
    s_setprio 1
    ds_read_b128 v[8:11], v224
    ds_read_b64_tr_b16 v[64:65], v2 offset:320
    ds_read_b64_tr_b16 v[66:67], v2 offset:1856
    ds_read_b128 v[12:15], v224 offset:32
    ds_read_b64_tr_b16 v[68:69], v2 offset:6464
    ds_read_b64_tr_b16 v[70:71], v2 offset:8000
    s_mov_b64 exec, s[36:37]
    ds_read_b128 v[32:35], v225
    ds_read_b128 v[36:39], v225 offset:32
    s_mov_b64 exec, -1
    ds_read_b64_tr_b16 v[56:57], v1 offset:128
    ds_read_b64_tr_b16 v[58:59], v1 offset:1664
    ds_read_b64_tr_b16 v[60:61], v1 offset:6272
    ds_read_b64_tr_b16 v[62:63], v1 offset:7808
    s_mov_b64 exec, s[36:37]
    ds_read_b128 v[40:43], v225 offset:64
    ds_read_b128 v[44:47], v225 offset:96
    s_mov_b64 exec, -1
    s_mov_b64 exec, s[36:37]
    ds_read_b128 v[48:51], v225 offset:128
    ds_read_b128 v[52:55], v225 offset:160
    s_mov_b64 exec, -1
    ds_read_b128 v[16:19], v224 offset:64
    ds_read_b128 v[20:23], v224 offset:96
    ds_read_b128 v[24:27], v224 offset:128
    ds_read_b128 v[28:31], v224 offset:160
    s_setprio 3
    s_waitcnt lgkmcnt(15)
    v_mfma_f32_32x32x16_bf16 v[192:207], v[64:67], v[8:11], 0
    s_waitcnt lgkmcnt(14)
    v_mfma_f32_32x32x16_bf16 v[192:207], v[68:71], v[12:15], v[192:207]
    s_cmp_eq_u32 s50, 0
    s_cbranch_scc0 L_c02
    s_mov_b32 exec_hi, 0xffff
    s_add_u32 m0, s27, 40064
    s_add_u32 s29, s26, 9216
    buffer_load_dwordx4 v72, s[64:67], s29 offen lds
    s_add_u32 m0, s27, 40832
    s_add_u32 s29, s26, 11520
    buffer_load_dwordx4 v72, s[64:67], s29 offen lds
    s_mov_b32 exec_hi, -1
L_c02:
    s_setprio 2
    s_waitcnt lgkmcnt(10)
    v_mfma_f32_32x32x16_bf16 v[160:175], v[56:59], v[8:11], 0
    ds_read_b32 v158, v141
    v_mfma_f32_32x32x16_bf16 v[176:191], v[56:59], v[32:35], 0
    ds_read_b64_tr_b16 v[56:57], v111 offset:192
    ds_read_b64_tr_b16 v[58:59], v111 offset:1728
    s_cmp_eq_u32 s50, 0
    s_cbranch_scc0 L_c00
    s_mov_b32 exec_hi, 0xffff
    s_add_u32 m0, s27, 36992
    s_add_u32 s29, s26, 0
    buffer_load_dwordx4 v72, s[64:67], s29 offen lds
    s_add_u32 m0, s27, 37760
    s_add_u32 s29, s26, 2304
    buffer_load_dwordx4 v72, s[64:67], s29 offen lds
    s_mov_b32 exec_hi, -1
L_c00:
    s_waitcnt lgkmcnt(11)
    v_mfma_f32_32x32x16_bf16 v[160:175], v[60:63], v[12:15], v[160:175]
    v_mfma_f32_32x32x16_bf16 v[176:191], v[60:63], v[36:39], v[176:191]
    ds_read_b64_tr_b16 v[60:61], v111 offset:6336
    ds_read_b64_tr_b16 v[62:63], v111 offset:7872
    s_waitcnt lgkmcnt(4)
    v_cmp_gt_u32 vcc, 2, v158
    s_cbranch_vccnz L_w10
L_b10:
    v_mfma_f32_32x32x16_bf16 v[208:223], v[64:67], v[32:35], 0
    ds_read_b64_tr_b16 v[64:65], v1 offset:12416
    ds_read_b64_tr_b16 v[66:67], v1 offset:13952
    s_cmp_eq_u32 s50, 0
    s_cbranch_scc0 L_c01
    s_mov_b32 exec_hi, 0xffff
    s_add_u32 m0, s27, 38528
    s_add_u32 s29, s26, 4608
    buffer_load_dwordx4 v72, s[64:67], s29 offen lds
    s_add_u32 m0, s27, 39296
    s_add_u32 s29, s26, 6912
    buffer_load_dwordx4 v72, s[64:67], s29 offen lds
    s_mov_b32 exec_hi, -1
L_c01:
    s_waitcnt lgkmcnt(4)
    v_mfma_f32_32x32x16_bf16 v[224:239], v[56:59], v[8:11], 0
    v_mfma_f32_32x32x16_bf16 v[240:255], v[56:59], v[32:35], 0
    ds_read_b64_tr_b16 v[56:57], v2 offset:12608
    ds_read_b64_tr_b16 v[58:59], v2 offset:14144
    v_mfma_f32_32x32x16_bf16 v[208:223], v[68:71], v[36:39], v[208:223]
    ds_read_b64_tr_b16 v[68:69], v1 offset:18560
    ds_read_b64_tr_b16 v[70:71], v1 offset:20096
    s_waitcnt lgkmcnt(6)
    v_mfma_f32_32x32x16_bf16 v[224:239], v[60:63], v[12:15], v[224:239]
    v_mfma_f32_32x32x16_bf16 v[240:255], v[60:63], v[36:39], v[240:255]
    ds_read_b64_tr_b16 v[60:61], v2 offset:18752
    ds_read_b64_tr_b16 v[62:63], v2 offset:20288
    s_waitcnt lgkmcnt(6)
    v_mfma_f32_32x32x16_bf16 v[160:175], v[64:67], v[16:19], v[160:175]
    s_waitcnt lgkmcnt(4)
    v_mfma_f32_32x32x16_bf16 v[192:207], v[56:59], v[16:19], v[192:207]
    v_mfma_f32_32x32x16_bf16 v[176:191], v[64:67], v[40:43], v[176:191]
    ds_read_b64_tr_b16 v[64:65], v111 offset:12480
    ds_read_b64_tr_b16 v[66:67], v111 offset:14016
    v_mfma_f32_32x32x16_bf16 v[208:223], v[56:59], v[40:43], v[208:223]
    s_waitcnt lgkmcnt(2)
    v_mfma_f32_32x32x16_bf16 v[192:207], v[60:63], v[20:23], v[192:207]
    v_mfma_f32_32x32x16_bf16 v[160:175], v[68:71], v[20:23], v[160:175]
    ds_read_b32 v158, v141
    v_mfma_f32_32x32x16_bf16 v[176:191], v[68:71], v[44:47], v[176:191]
    ds_read_b64_tr_b16 v[68:69], v111 offset:18624
    ds_read_b64_tr_b16 v[70:71], v111 offset:20160
    v_mfma_f32_32x32x16_bf16 v[208:223], v[60:63], v[44:47], v[208:223]
    s_waitcnt lgkmcnt(3)
    v_mfma_f32_32x32x16_bf16 v[224:239], v[64:67], v[16:19], v[224:239]
    v_mfma_f32_32x32x16_bf16 v[240:255], v[64:67], v[40:43], v[240:255]
    s_waitcnt lgkmcnt(2)
    v_cmp_gt_u32 vcc, 3, v158
    s_cbranch_vccnz L_w20
L_b20:
    ds_read_b64_tr_b16 v[56:57], v1 offset:24704
    ds_read_b64_tr_b16 v[58:59], v1 offset:26240
    s_waitcnt lgkmcnt(2)
    v_mfma_f32_32x32x16_bf16 v[224:239], v[68:71], v[20:23], v[224:239]
    ds_read_b64_tr_b16 v[60:61], v1 offset:30848
    ds_read_b64_tr_b16 v[62:63], v1 offset:32384
    ds_read_b64_tr_b16 v[64:65], v2 offset:24896
    ds_read_b64_tr_b16 v[66:67], v2 offset:26432
    v_mfma_f32_32x32x16_bf16 v[240:255], v[68:71], v[44:47], v[240:255]
    ds_read_b64_tr_b16 v[68:69], v2 offset:31040
    ds_read_b64_tr_b16 v[70:71], v2 offset:32576
    s_waitcnt vmcnt(0)
    s_mov_b64 exec, s[24:25]
    ds_write_b8 v141, v127
    s_mov_b64 exec, -1
    s_waitcnt lgkmcnt(7)
    v_mfma_f32_32x32x16_bf16 v[160:175], v[56:59], v[24:27], v[160:175]
    s_waitcnt lgkmcnt(5)
    v_mfma_f32_32x32x16_bf16 v[160:175], v[60:63], v[28:31], v[160:175]
    v_mfma_f32_32x32x16_bf16 v[176:191], v[56:59], v[48:51], v[176:191]
    ds_read_b64_tr_b16 v[56:57], v111 offset:24768
    ds_read_b64_tr_b16 v[58:59], v111 offset:26304
    ds_read_b32 v158, v141
    v_mfma_f32_32x32x16_bf16 v[176:191], v[60:63], v[52:55], v[176:191]
    ds_read_b64_tr_b16 v[60:61], v111 offset:30912
    ds_read_b64_tr_b16 v[62:63], v111 offset:32448
    s_nop 4
    v_mul_f32 v160, s4, v160
    v_mul_f32 v161, s4, v161
    v_mul_f32 v162, s4, v162
    s_waitcnt lgkmcnt(8)
    v_mfma_f32_32x32x16_bf16 v[192:207], v[64:67], v[24:27], v[192:207]
    v_mul_f32 v163, s4, v163
    v_mul_f32 v164, s4, v164
    v_mul_f32 v165, s4, v165
    v_mul_f32 v166, s4, v166
    v_mul_f32 v167, s4, v167
    v_mfma_f32_32x32x16_bf16 v[208:223], v[64:67], v[48:51], v[208:223]
    v_mul_f32 v168, s4, v168
    v_mul_f32 v169, s4, v169
    v_mul_f32 v170, s4, v170
    v_mul_f32 v171, s4, v171
    s_cmp_eq_u32 s50, 0
    s_cbranch_scc0 L_c03
    s_add_u32 m0, s28, 55424
    s_add_u32 s29, s28, 0
    buffer_load_dwordx4 v73, s[40:43], s29 offen lds
    s_add_u32 m0, s28, 59520
    s_add_u32 s29, s28, 4096
    buffer_load_dwordx4 v73, s[40:43], s29 offen lds
L_c03:
    s_waitcnt lgkmcnt(5)
    v_mfma_f32_32x32x16_bf16 v[192:207], v[68:71], v[28:31], v[192:207]
    v_mul_f32 v172, s4, v172
    v_mul_f32 v173, s4, v173
    v_mul_f32 v174, s4, v174
    s_waitcnt lgkmcnt(2)
    v_cmp_gt_u32 vcc, 4, v158
    s_cbranch_vccnz L_w30
L_b30:
    v_mul_f32 v175, s4, v175
    v_mfma_f32_32x32x16_bf16 v[208:223], v[68:71], v[52:55], v[208:223]
    ds_read_b64_tr_b16 v[64:65], v7
    ds_read_b64_tr_b16 v[66:67], v7 offset:768
    ds_read_b64_tr_b16 v[68:69], v7 offset:3072
    ds_read_b64_tr_b16 v[70:71], v7 offset:3840
    v_mul_f32 v176, s4, v176
    s_cmp_eq_u32 s50, 0
    s_cbranch_scc0 L_c04
    s_add_u32 m0, s28, 63616
    s_add_u32 s29, s28, 8192
    buffer_load_dwordx4 v73, s[40:43], s29 offen lds
    s_add_u32 m0, s28, 67712
    s_add_u32 s29, s28, 12288
    buffer_load_dwordx4 v73, s[40:43], s29 offen lds
L_c04:
    v_mfma_f32_32x32x16_bf16 v[224:239], v[56:59], v[24:27], v[224:239]
    v_mul_f32 v177, s4, v177
    v_mul_f32 v178, s4, v178
    v_mul_f32 v179, s4, v179
    v_mul_f32 v180, s4, v180
    v_mul_f32 v181, s4, v181
    v_mfma_f32_32x32x16_bf16 v[240:255], v[56:59], v[48:51], v[240:255]
    ds_read_b64_tr_b16 v[56:57], v7 offset:6144
    ds_read_b64_tr_b16 v[58:59], v7 offset:6912
    v_mul_f32 v182, s4, v182
    v_mul_f32 v183, s4, v183
    v_mul_f32 v184, s4, v184
    s_waitcnt lgkmcnt(6)
    v_mfma_f32_32x32x16_bf16 v[224:239], v[60:63], v[28:31], v[224:239]
    s_cmp_eq_u32 s50, 0
    s_cbranch_scc0 L_c05
    s_add_u32 s29, s28, 16384
    s_min_u32 s29, s29, 17408
    s_add_u32 m0, s29, 55424
    s_nop 0
    buffer_load_dwordx4 v73, s[40:43], s29 offen lds
L_c05:
    v_mul_f32 v185, s4, v185
    v_mfma_f32_32x32x16_bf16 v[240:255], v[60:63], v[52:55], v[240:255]
    ds_read_b64_tr_b16 v[60:61], v7 offset:9216
    ds_read_b64_tr_b16 v[62:63], v7 offset:9984
    v_mul_f32 v186, s4, v186
    v_mul_f32 v187, s4, v187
    v_mul_f32 v188, s4, v188
    s_setprio 1
    v_mul_f32 v189, s4, v189
    v_mul_f32 v190, s4, v190
    v_mul_f32 v191, s4, v191
    v_cvt_pk_bf16_f32 v72, v160, v161
    v_cvt_pk_bf16_f32 v73, v162, v163
    v_cvt_pk_bf16_f32 v74, v164, v165
    v_cvt_pk_bf16_f32 v75, v166, v167
    v_cvt_pk_bf16_f32 v76, v168, v169
    v_cvt_pk_bf16_f32 v77, v170, v171
    v_cvt_pk_bf16_f32 v80, v172, v173
    v_cvt_pk_bf16_f32 v81, v174, v175
    s_waitcnt lgkmcnt(4)
    v_mfma_f32_32x32x16_bf16 v[160:175], v[8:11], v[64:67], 0
    v_cvt_pk_bf16_f32 v86, v176, v177
    v_cvt_pk_bf16_f32 v87, v178, v179
    v_cvt_pk_bf16_f32 v88, v180, v181
    v_cvt_pk_bf16_f32 v89, v182, v183
    v_cvt_pk_bf16_f32 v90, v184, v185
    v_mfma_f32_32x32x16_bf16 v[160:175], v[12:15], v[68:71], v[160:175]
    v_cvt_pk_bf16_f32 v91, v186, v187
    v_cvt_pk_bf16_f32 v94, v188, v189
    v_cvt_pk_bf16_f32 v95, v190, v191
    v_mul_f32 v224, s4, v224
    v_mul_f32 v225, s4, v225
    v_mfma_f32_32x32x16_bf16 v[176:191], v[32:35], v[64:67], 0
    ds_read_b64_tr_b16 v[64:65], v7 offset:12288
    ds_read_b64_tr_b16 v[66:67], v7 offset:13056
    v_mul_f32 v226, s4, v226
    v_mul_f32 v227, s4, v227
    v_mul_f32 v228, s4, v228
    s_waitcnt lgkmcnt(2)
    v_mfma_f32_32x32x16_bf16 v[160:175], v[16:19], v[56:59], v[160:175]
    v_mul_f32 v229, s4, v229
    v_mul_f32 v230, s4, v230
    v_mul_f32 v231, s4, v231
    v_cvt_pk_bf16_f32 v82, v224, v225
    v_cvt_pk_bf16_f32 v83, v226, v227
    v_mfma_f32_32x32x16_bf16 v[176:191], v[36:39], v[68:71], v[176:191]
    ds_read_b64_tr_b16 v[68:69], v7 offset:15360
    ds_read_b64_tr_b16 v[70:71], v7 offset:16128
    v_cvt_pk_bf16_f32 v84, v228, v229
    v_cvt_pk_bf16_f32 v85, v230, v231
    v_cvt_pk_bf16_f32 v110, v232, v233
    v_mfma_f32_32x32x16_bf16 v[160:175], v[20:23], v[60:63], v[160:175]
    v_cvt_pk_bf16_f32 v111, v234, v235
    v_cvt_pk_bf16_f32 v112, v236, v237
    v_cvt_pk_bf16_f32 v113, v238, v239
    ds_read_b128 v[224:227], v5
    ds_read_b128 v[228:231], v5 offset:128
    v_mfma_f32_32x32x16_bf16 v[176:191], v[40:43], v[56:59], v[176:191]
    ds_read_b64_tr_b16 v[56:57], v7 offset:48
    ds_read_b64_tr_b16 v[58:59], v7 offset:816
    ds_read_b128 v[232:235], v5 offset:256
    ds_read_b96 v[236:238], v5 offset:16
    ds_read_b32 v239, v142 offset:384
    v_mul_f32 v240, s4, v240
    v_mfma_f32_32x32x16_bf16 v[176:191], v[44:47], v[60:63], v[176:191]
    ds_read_b64_tr_b16 v[60:61], v7 offset:3120
    ds_read_b64_tr_b16 v[62:63], v7 offset:3888
    v_mul_f32 v241, s4, v241
    v_mul_f32 v242, s4, v242
    v_mul_f32 v243, s4, v243
    s_waitcnt lgkmcnt(11)
    v_mfma_f32_32x32x16_bf16 v[160:175], v[24:27], v[64:67], v[160:175]
    v_mul_f32 v244, s4, v244
    v_mul_f32 v245, s4, v245
    v_mul_f32 v246, s4, v246
    v_mul_f32 v247, s4, v247
    v_cvt_pk_bf16_f32 v100, v192, v193
    v_mfma_f32_32x32x16_bf16 v[176:191], v[48:51], v[64:67], v[176:191]
    ds_read_b64_tr_b16 v[64:65], v7 offset:6192
    ds_read_b64_tr_b16 v[66:67], v7 offset:6960
    v_cvt_pk_bf16_f32 v101, v194, v195
    v_cvt_pk_bf16_f32 v102, v196, v197
    v_cvt_pk_bf16_f32 v103, v198, v199
    s_waitcnt lgkmcnt(11)
    v_mfma_f32_32x32x16_bf16 v[160:175], v[28:31], v[68:71], v[160:175]
    v_cvt_pk_bf16_f32 v104, v200, v201
    v_cvt_pk_bf16_f32 v105, v202, v203
    v_cvt_pk_bf16_f32 v108, v204, v205
    v_cvt_pk_bf16_f32 v109, v206, v207
    v_cvt_pk_bf16_f32 v114, v208, v209
    v_mfma_f32_32x32x16_bf16 v[176:191], v[52:55], v[68:71], v[176:191]
    ds_read_b64_tr_b16 v[68:69], v7 offset:9264
    ds_read_b64_tr_b16 v[70:71], v7 offset:10032
    v_cvt_pk_bf16_f32 v115, v210, v211
    v_cvt_pk_bf16_f32 v116, v212, v213
    v_cvt_pk_bf16_f32 v117, v214, v215
    s_waitcnt lgkmcnt(4)
    v_mfma_f32_32x32x16_bf16 v[192:207], v[8:11], v[56:59], 0
    s_mov_b64 exec, s[60:61]
    v_cvt_pk_bf16_f32 v128, v160, v161
    v_cvt_pk_bf16_f32 v129, v162, v163
    v_cvt_pk_bf16_f32 v130, v164, v165
    v_cvt_pk_bf16_f32 v131, v166, v167
    v_cvt_pk_bf16_f32 v132, v168, v169
    v_cvt_pk_bf16_f32 v133, v170, v171
    v_cvt_pk_bf16_f32 v134, v172, v173
    v_cvt_pk_bf16_f32 v135, v174, v175
    s_mov_b64 exec, -1
    v_mfma_f32_32x32x16_bf16 v[192:207], v[12:15], v[60:63], v[192:207]
    v_cvt_pk_bf16_f32 v118, v216, v217
    v_cvt_pk_bf16_f32 v119, v218, v219
    v_cvt_pk_bf16_f32 v122, v220, v221
    v_cvt_pk_bf16_f32 v123, v222, v223
    v_cvt_pk_bf16_f32 v96, v240, v241
    v_mfma_f32_32x32x16_bf16 v[208:223], v[32:35], v[56:59], 0
    v_cvt_pk_bf16_f32 v97, v242, v243
    v_cvt_pk_bf16_f32 v98, v244, v245
    v_cvt_pk_bf16_f32 v99, v246, v247
    v_cvt_pk_bf16_f32 v124, v248, v249
    ds_read_b96 v[240:242], v5 offset:144
    v_mfma_f32_32x32x16_bf16 v[208:223], v[36:39], v[60:63], v[208:223]
    ds_read_b32 v243, v142 offset:392
    ds_read_b96 v[244:246], v5 offset:272
    ds_read_b32 v247, v142 offset:400
    ds_read_b32 v248, v159 offset:408
    s_mov_b64 exec, s[60:61]
    v_cvt_pk_bf16_f32 v136, v176, v177
    v_cvt_pk_bf16_f32 v137, v178, v179
    v_cvt_pk_bf16_f32 v138, v180, v181
    v_cvt_pk_bf16_f32 v139, v182, v183
    v_cvt_pk_bf16_f32 v140, v184, v185
    s_mov_b64 exec, -1
    s_waitcnt lgkmcnt(5)
    v_mfma_f32_32x32x16_bf16 v[192:207], v[16:19], v[64:67], v[192:207]
    ds_read_b64_tr_b16 v[56:57], v7 offset:12336
    ds_read_b64_tr_b16 v[58:59], v7 offset:13104
    ds_read_b128 v[160:163], v5 offset:3392
    ds_read_b128 v[164:167], v5 offset:3520
    ds_read_b128 v[168:171], v5 offset:3648
    ds_read_b96 v[172:174], v5 offset:3408
    v_mfma_f32_32x32x16_bf16 v[192:207], v[20:23], v[68:71], v[192:207]
    ds_read_b32 v175, v142 offset:3776
    ds_read_b96 v[176:178], v5 offset:3536
    ds_read_b32 v179, v142 offset:3784
    ds_read_b96 v[180:182], v5 offset:3664
    ds_read_b32 v183, v142 offset:3792
    ds_read_b32 v184, v159 offset:3800
    v_mfma_f32_32x32x16_bf16 v[224:239], v[100:103], v[86:89], v[224:239]
    ds_read_b64_tr_b16 v[60:61], v7 offset:15408
    ds_read_b64_tr_b16 v[62:63], v7 offset:16176
    v_cvt_pk_bf16_f32 v125, v250, v251
    v_cvt_pk_bf16_f32 v126, v252, v253
    v_cvt_pk_bf16_f32 v127, v254, v255
    v_mfma_f32_32x32x16_bf16 v[208:223], v[40:43], v[64:67], v[208:223]
    v_lshrrev_b32 v20, 20, v157
    v_add_u32 v22, 32, v0
    v_add_u32 v20, s72, v20
    s_nop 0
    v_permlane16_swap_b32 v0, v22
    s_waitcnt lgkmcnt(14)
    v_mfma_f32_32x32x16_bf16 v[240:255], v[114:117], v[86:89], v[240:255]
    s_waitcnt lgkmcnt(12)
    v_mfma_f32_32x32x16_bf16 v[192:207], v[24:27], v[56:59], v[192:207]
    s_waitcnt lgkmcnt(7)
    v_mfma_f32_32x32x16_bf16 v[160:175], v[106:109], v[92:95], v[160:175]
    v_mfma_f32_32x32x16_bf16 v[224:239], v[104:107], v[90:93], v[224:239]
    s_waitcnt lgkmcnt(2)
    v_mfma_f32_32x32x16_bf16 v[176:191], v[120:123], v[92:95], v[176:191]
    s_nop 9
    v_exp_f32 v224, v224
    v_mfma_f32_32x32x16_bf16 v[240:255], v[118:121], v[90:93], v[240:255]
    v_exp_f32 v225, v225
    v_exp_f32 v226, v226
    v_exp_f32 v227, v227
    s_waitcnt lgkmcnt(0)
    v_mfma_f32_32x32x16_bf16 v[192:207], v[28:31], v[60:63], v[192:207]
    v_exp_f32 v228, v228
    v_exp_f32 v229, v229
    v_exp_f32 v230, v230
    v_mfma_f32_32x32x16_bf16 v[160:175], v[110:113], v[96:99], v[160:175]
    v_exp_f32 v231, v231
    v_exp_f32 v232, v232
    v_exp_f32 v233, v233
    v_mfma_f32_32x32x16_bf16 v[208:223], v[44:47], v[68:71], v[208:223]
    v_exp_f32 v234, v234
    v_exp_f32 v235, v235
    v_exp_f32 v236, v236
    v_mfma_f32_32x32x16_bf16 v[176:191], v[124:127], v[96:99], v[176:191]
    v_exp_f32 v237, v237
    v_cvt_pk_bf16_f32 v224, v224, v225
    v_exp_f32 v240, v240
    v_mfma_f32_32x32x16_bf16 v[208:223], v[48:51], v[56:59], v[208:223]
    v_exp_f32 v241, v241
    v_exp_f32 v242, v242
    s_setprio 0
    v_exp_f32 v243, v243
    s_setprio 2
    v_mfma_f32_32x32x16_bf16 v[208:223], v[52:55], v[60:63], v[208:223]
    s_setprio 0
    v_exp_f32 v244, v244
    v_exp_f32 v245, v245
    v_exp_f32 v246, v246
    v_exp_f32 v247, v247
    v_exp_f32 v248, v248
    v_cvt_pk_bf16_f32 v225, v226, v227
    v_cvt_pk_bf16_f32 v226, v228, v229
    v_cvt_pk_bf16_f32 v227, v230, v231
    s_mov_b64 exec, s[60:61]
    v_cvt_pk_bf16_f32 v144, v192, v193
    v_cvt_pk_bf16_f32 v145, v194, v195
    v_cvt_pk_bf16_f32 v146, v196, v197
    v_cvt_pk_bf16_f32 v147, v198, v199
    v_cvt_pk_bf16_f32 v148, v200, v201
    v_cvt_pk_bf16_f32 v149, v202, v203
    v_cvt_pk_bf16_f32 v150, v204, v205
    v_cvt_pk_bf16_f32 v151, v206, v207
    s_mov_b64 exec, -1
    v_cvt_pk_bf16_f32 v228, v232, v233
    v_cvt_pk_bf16_f32 v229, v234, v235
    v_cvt_pk_bf16_f32 v230, v236, v237
    v_exp_f32 v160, v160
    v_exp_f32 v161, v161
    v_cvt_pk_bf16_f32 v232, v240, v241
    v_cvt_pk_bf16_f32 v233, v242, v243
    v_cvt_pk_bf16_f32 v234, v244, v245
    v_cvt_pk_bf16_f32 v235, v246, v247
    v_cvt_pk_bf16_f32 v236, v248, 0
    s_setprio 2
    v_mfma_f32_32x32x16_bf16 v[240:255], v[128:131], v[224:227], 0
    s_setprio 0
    v_exp_f32 v162, v162
    v_exp_f32 v163, v163
    v_exp_f32 v164, v164
    v_exp_f32 v165, v165
    v_exp_f32 v166, v166
    v_exp_f32 v167, v167
    v_exp_f32 v168, v168
    v_exp_f32 v169, v169
    v_exp_f32 v170, v170
    v_exp_f32 v171, v171
    v_exp_f32 v172, v172
    v_exp_f32 v173, v173
    v_cvt_pk_bf16_f32 v160, v160, v161
    v_exp_f32 v238, v238
    v_exp_f32 v239, v239
    v_exp_f32 v176, v176
    v_exp_f32 v177, v177
    v_exp_f32 v178, v178
    v_exp_f32 v179, v179
    v_exp_f32 v180, v180
    v_exp_f32 v181, v181
    v_exp_f32 v182, v182
    v_exp_f32 v183, v183
    v_exp_f32 v184, v184
    v_cvt_pk_bf16_f32 v161, v162, v163
    v_cvt_pk_bf16_f32 v162, v164, v165
    v_cvt_pk_bf16_f32 v163, v166, v167
    v_cvt_pk_bf16_f32 v164, v168, v169
    v_cvt_pk_bf16_f32 v165, v170, v171
    v_cvt_pk_bf16_f32 v166, v172, v173
    v_cvt_pk_bf16_f32 v231, v238, v239
    v_cvt_pk_bf16_f32 v168, v176, v177
    v_cvt_pk_bf16_f32 v169, v178, v179
    s_setprio 2
    v_mfma_f32_32x32x16_bf16 v[240:255], v[132:135], v[228:231], v[240:255]
    s_setprio 0
    v_cvt_pk_bf16_f32 v170, v180, v181
    s_setprio 1
    v_cvt_pk_bf16_f32 v171, v182, v183
    v_cvt_pk_bf16_f32 v172, v184, 0
    v_exp_f32 v174, v174
    v_mfma_f32_32x32x16_bf16 v[176:191], v[144:147], v[160:163], 0
    v_exp_f32 v175, v175
    s_mov_b64 exec, s[60:61]
    v_cvt_pk_bf16_f32 v152, v208, v209
    v_cvt_pk_bf16_f32 v153, v210, v211
    v_cvt_pk_bf16_f32 v154, v212, v213
    v_cvt_pk_bf16_f32 v155, v214, v215
    v_cvt_pk_bf16_f32 v156, v216, v217
    s_mov_b64 exec, -1
    v_mfma_f32_32x32x16_bf16 v[240:255], v[136:139], v[232:235], v[240:255]
    v_cvt_pk_bf16_f32 v167, v174, v175
    v_mov_b32 v237, 0
    v_mov_b32 v173, 0
    ds_read_b128 v[192:195], v4
    ds_read_b128 v[196:199], v4 offset:128
    v_mfma_f32_32x32x16_bf16 v[176:191], v[148:151], v[164:167], v[176:191]
    ds_read_b128 v[200:203], v4 offset:256
    ds_read_b96 v[204:206], v4 offset:16
    ds_read_b32 v207, v6 offset:384
    ds_read_b96 v[208:210], v4 offset:144
    ds_read_b32 v211, v6 offset:392
    ds_read_b96 v[212:214], v4 offset:272
    v_mfma_f32_32x32x16_bf16 v[176:191], v[152:155], v[168:171], v[176:191]
    ds_read_b32 v215, v6 offset:400
    ds_read_b32 v216, v143 offset:408
    v_mfma_f32_32x32x8bf16_1k v[240:255], v[140:141], v[236:237], v[240:255]
    v_mfma_f32_32x32x8bf16_1k v[176:191], v[156:157], v[172:173], v[176:191]
    s_nop 10
    v_rcp_f32 v253, v252
    v_subrev_u32 v254, s5, v252
    v_cmp_lt_u32 vcc, s11, v254
    v_mul_f32 v240, v253, v240
    v_mul_f32 v241, v253, v241
    s_cbranch_vccnz L_r001
L_q001:
    v_mul_f32 v242, v253, v242
    v_mul_f32 v243, v253, v243
    s_waitcnt lgkmcnt(5)
    v_mfma_f32_32x32x16_bf16 v[192:207], v[100:103], v[72:75], v[192:207]
    v_rcp_f32 v189, v188
    v_subrev_u32 v190, s5, v188
    v_cmp_lt_u32 vcc, s11, v190
    v_mul_f32 v176, v189, v176
    v_mul_f32 v177, v189, v177
    s_cbranch_vccnz L_r011
L_q011:
    s_waitcnt lgkmcnt(0)
    v_mfma_f32_32x32x16_bf16 v[208:223], v[114:117], v[72:75], v[208:223]
    v_mul_f32 v244, v253, v244
    v_mul_f32 v245, v253, v245
    v_mul_f32 v246, v253, v246
    v_mul_f32 v247, v253, v247
    v_mul_f32 v248, v253, v248
    s_setprio 2
    v_mfma_f32_32x32x16_bf16 v[192:207], v[104:107], v[76:79], v[192:207]
    s_setprio 0
    v_mul_f32 v249, v253, v249
    v_mul_f32 v250, v253, v250
    v_mul_f32 v251, v253, v251
    v_cvt_pk_bf16_f32 v86, v240, v241
    v_cvt_pk_bf16_f32 v87, v242, v243
    s_setprio 2
    v_mfma_f32_32x32x16_bf16 v[208:223], v[118:121], v[76:79], v[208:223]
    s_setprio 0
    v_cvt_pk_bf16_f32 v88, v244, v245
    v_cvt_pk_bf16_f32 v89, v246, v247
    v_mul_f32 v178, v189, v178
    v_mul_f32 v179, v189, v179
    v_cvt_pk_bf16_f32 v90, v248, v249
    v_cvt_pk_bf16_f32 v91, v250, v251
    v_mul_f32 v180, v189, v180
    v_mul_f32 v181, v189, v181
    v_mul_f32 v182, v189, v182
    v_mul_f32 v183, v189, v183
    v_mul_f32 v184, v189, v184
    v_mul_f32 v185, v189, v185
    v_mul_f32 v186, v189, v186
    v_mul_f32 v187, v189, v187
    v_cvt_pk_bf16_f32 v92, v176, v177
    v_cvt_pk_bf16_f32 v93, v178, v179
    ds_write_b128 v20, v[86:89]
    v_cvt_pk_bf16_f32 v94, v180, v181
    v_cvt_pk_bf16_f32 v95, v182, v183
    v_cvt_pk_bf16_f32 v96, v184, v185
    v_cvt_pk_bf16_f32 v97, v186, v187
    ds_write_b128 v20, v[90:93] offset:1024
    s_waitcnt vmcnt(0)
    s_mov_b64 exec, s[24:25]
    ds_write_b8 v141, v157
    s_mov_b64 exec, -1
    ds_write_b128 v20, v[94:97] offset:2048
    ds_read_b128 v[224:227], v4 offset:3392
    ds_read_b128 v[228:231], v4 offset:3520
    ds_read_b128 v[232:235], v4 offset:3648
    ds_read_b96 v[236:238], v4 offset:3408
    ds_read_b32 v239, v6 offset:3776
    s_mov_b64 exec, s[6:7]
    ds_write_b8_d16_hi v141, v157
    s_mov_b64 exec, -1
    ds_read_b96 v[240:242], v4 offset:3536
    ds_read_b32 v243, v6 offset:3784
    ds_read_b96 v[244:246], v4 offset:3664
    ds_read_b32 v247, v6 offset:3792
    ds_read_b32 v248, v143 offset:3800
    v_exp_f32 v192, v192
    v_exp_f32 v193, v193
    v_exp_f32 v194, v194
    v_exp_f32 v195, v195
    v_exp_f32 v196, v196
    v_exp_f32 v197, v197
    v_exp_f32 v198, v198
    v_exp_f32 v199, v199
    v_exp_f32 v200, v200
    v_exp_f32 v201, v201
    v_exp_f32 v202, v202
    s_setprio 2
    s_waitcnt lgkmcnt(6)
    v_mfma_f32_32x32x16_bf16 v[224:239], v[106:109], v[78:81], v[224:239]
    s_setprio 0
    v_exp_f32 v203, v203
    v_exp_f32 v204, v204
    v_exp_f32 v205, v205
    s_setprio 2
    s_waitcnt lgkmcnt(0)
    v_mfma_f32_32x32x16_bf16 v[240:255], v[120:123], v[78:81], v[240:255]
    s_setprio 0
    v_cvt_pk_bf16_f32 v192, v192, v193
    v_exp_f32 v208, v208
    v_exp_f32 v209, v209
    s_setprio 2
    v_mfma_f32_32x32x16_bf16 v[224:239], v[110:113], v[82:85], v[224:239]
    s_setprio 0
    v_exp_f32 v210, v210
    v_exp_f32 v211, v211
    v_exp_f32 v212, v212
    s_setprio 1
    v_mfma_f32_32x32x16_bf16 v[240:255], v[124:127], v[82:85], v[240:255]
    v_exp_f32 v213, v213
    v_exp_f32 v214, v214
    s_setprio 0
    v_exp_f32 v215, v215
    v_exp_f32 v216, v216
    v_cvt_pk_bf16_f32 v193, v194, v195
    v_cvt_pk_bf16_f32 v194, v196, v197
    v_cvt_pk_bf16_f32 v195, v198, v199
    v_cvt_pk_bf16_f32 v196, v200, v201
    v_cvt_pk_bf16_f32 v197, v202, v203
    v_cvt_pk_bf16_f32 v198, v204, v205
    v_exp_f32 v224, v224
    v_exp_f32 v225, v225
    v_cvt_pk_bf16_f32 v200, v208, v209
    v_cvt_pk_bf16_f32 v201, v210, v211
    v_cvt_pk_bf16_f32 v202, v212, v213
    v_cvt_pk_bf16_f32 v203, v214, v215
    v_cvt_pk_bf16_f32 v204, v216, 0
    s_setprio 2
    v_mfma_f32_32x32x16_bf16 v[208:223], v[128:131], v[192:195], 0
    s_setprio 0
    v_exp_f32 v226, v226
    v_exp_f32 v227, v227
    v_exp_f32 v228, v228
    v_exp_f32 v229, v229
    v_exp_f32 v230, v230
    v_exp_f32 v231, v231
    v_exp_f32 v232, v232
    v_exp_f32 v233, v233
    v_exp_f32 v234, v234
    v_exp_f32 v235, v235
    v_exp_f32 v236, v236
    v_exp_f32 v237, v237
    v_cvt_pk_bf16_f32 v224, v224, v225
    v_exp_f32 v206, v206
    v_exp_f32 v207, v207
    v_exp_f32 v240, v240
    v_exp_f32 v241, v241
    v_exp_f32 v242, v242
    v_exp_f32 v243, v243
    v_exp_f32 v244, v244
    v_exp_f32 v245, v245
    v_exp_f32 v246, v246
    v_exp_f32 v247, v247
    v_exp_f32 v248, v248
    v_cvt_pk_bf16_f32 v225, v226, v227
    v_cvt_pk_bf16_f32 v226, v228, v229
    v_cvt_pk_bf16_f32 v227, v230, v231
    v_cvt_pk_bf16_f32 v228, v232, v233
    v_cvt_pk_bf16_f32 v229, v234, v235
    v_cvt_pk_bf16_f32 v230, v236, v237
    v_cvt_pk_bf16_f32 v199, v206, v207
    v_cvt_pk_bf16_f32 v232, v240, v241
    v_cvt_pk_bf16_f32 v233, v242, v243
    s_setprio 2
    v_mfma_f32_32x32x16_bf16 v[208:223], v[132:135], v[196:199], v[208:223]
    s_setprio 1
    v_cvt_pk_bf16_f32 v234, v244, v245
    v_cvt_pk_bf16_f32 v235, v246, v247
    v_cvt_pk_bf16_f32 v236, v248, 0
    v_exp_f32 v238, v238
    v_mfma_f32_32x32x16_bf16 v[240:255], v[144:147], v[224:227], 0
    v_exp_f32 v239, v239
    ds_read_b32 v21, v141
    ds_read_b128 v[8:11], v20 offset:3072
    ds_read_b128 v[12:15], v20 offset:4096
    ds_read_b128 v[16:19], v20 offset:5120
    v_mfma_f32_32x32x16_bf16 v[208:223], v[136:139], v[200:203], v[208:223]
    v_cvt_pk_bf16_f32 v231, v238, v239
    v_mov_b32 v205, 0
    v_mov_b32 v237, 0
    v_mfma_f32_32x32x16_bf16 v[240:255], v[148:151], v[228:231], v[240:255]
    v_mfma_f32_32x32x16_bf16 v[240:255], v[152:155], v[232:235], v[240:255]
    v_mfma_f32_32x32x8bf16_1k v[208:223], v[140:141], v[204:205], v[208:223]
    v_mfma_f32_32x32x8bf16_1k v[240:255], v[156:157], v[236:237], v[240:255]
    s_setprio 0
    s_nop 9
    v_rcp_f32 v221, v220
    v_subrev_u32 v222, s5, v220
    v_cmp_lt_u32 vcc, s11, v222
    v_mul_f32 v208, v221, v208
    v_mul_f32 v209, v221, v209
    s_cbranch_vccnz L_r000
L_q000:
    v_mul_f32 v210, v221, v210
    v_mul_f32 v211, v221, v211
    v_rcp_f32 v253, v252
    v_subrev_u32 v254, s5, v252
    v_cmp_lt_u32 vcc, s11, v254
    v_mul_f32 v240, v253, v240
    v_mul_f32 v241, v253, v241
    s_cbranch_vccnz L_r010
L_q010:
    s_waitcnt lgkmcnt(0)
    v_cmp_gt_u32 vcc, 7, v21
    v_cmp_gt_u32 s[74:75], 6, v21
    s_and_b32 s70, vcc_lo, s63
    s_or_b32 s70, s70, s74
    s_cbranch_scc1 L_wait0
L_back0:
    ds_read_b64_tr_b16 v[64:65], v3 offset:9216
    ds_read_b64_tr_b16 v[66:67], v3 offset:10752
    ds_read_b64_tr_b16 v[68:69], v3 offset:9280
    ds_read_b64_tr_b16 v[70:71], v3 offset:10816
    ds_read_b64_tr_b16 v[56:57], v3 offset:9344
    ds_read_b64_tr_b16 v[58:59], v3 offset:10880
    ds_read_b64_tr_b16 v[60:61], v3 offset:12288
    ds_read_b64_tr_b16 v[62:63], v3 offset:13824
    v_mul_f32 v212, v221, v212
    v_mul_f32 v213, v221, v213
    v_mul_f32 v214, v221, v214
    v_mul_f32 v215, v221, v215
    v_cvt_pk_bf16_f32 v72, v208, v209
    v_cvt_pk_bf16_f32 v73, v210, v211
    v_cvt_pk_bf16_f32 v74, v212, v213
    v_cvt_pk_bf16_f32 v75, v214, v215
    v_mul_f32 v216, v221, v216
    v_mul_f32 v217, v221, v217
    v_mul_f32 v218, v221, v218
    v_mul_f32 v219, v221, v219
    v_mul_f32 v242, v253, v242
    v_mul_f32 v243, v253, v243
    v_cvt_pk_bf16_f32 v76, v216, v217
    v_cvt_pk_bf16_f32 v77, v218, v219
    v_cvt_pk_bf16_f32 v78, v240, v241
    v_cvt_pk_bf16_f32 v79, v242, v243
    v_mul_f32 v244, v253, v244
    v_mul_f32 v245, v253, v245
    v_mul_f32 v246, v253, v246
    v_mul_f32 v247, v253, v247
    v_mul_f32 v248, v253, v248
    s_setprio 2
    s_waitcnt lgkmcnt(5)
    v_mfma_f32_32x32x16_bf16 v[24:39], v[64:67], v[8:11], 0
    ds_read_b64_tr_b16 v[64:65], v3 offset:12352
    ds_read_b64_tr_b16 v[66:67], v3 offset:13888
    s_setprio 0
    v_mul_f32 v249, v253, v249
    v_mul_f32 v250, v253, v250
    s_setprio 1
    v_mul_f32 v251, v253, v251
    s_waitcnt lgkmcnt(2)
    v_mfma_f32_32x32x16_bf16 v[40:55], v[68:71], v[8:11], 0
    ds_read_b64_tr_b16 v[68:69], v3 offset:12416
    ds_read_b64_tr_b16 v[70:71], v3 offset:13952
    v_cvt_pk_bf16_f32 v80, v244, v245
    v_cvt_pk_bf16_f32 v81, v246, v247
    v_cvt_pk_bf16_f32 v82, v248, v249
    v_mfma_f32_32x32x16_bf16 v[160:175], v[56:59], v[8:11], 0
    ds_read_b64_tr_b16 v[56:57], v3 offset:15360
    ds_read_b64_tr_b16 v[58:59], v3 offset:16896
    v_cvt_pk_bf16_f32 v83, v250, v251
    v_mfma_f32_32x32x16_bf16 v[24:39], v[60:63], v[12:15], v[24:39]
    ds_read_b64_tr_b16 v[60:61], v3 offset:15424
    ds_read_b64_tr_b16 v[62:63], v3 offset:16960
    s_waitcnt lgkmcnt(6)
    v_mfma_f32_32x32x16_bf16 v[40:55], v[64:67], v[12:15], v[40:55]
    ds_read_b64_tr_b16 v[64:65], v3 offset:15488
    ds_read_b64_tr_b16 v[66:67], v3 offset:17024
    s_waitcnt lgkmcnt(6)
    v_mfma_f32_32x32x16_bf16 v[160:175], v[68:71], v[12:15], v[160:175]
    ds_read_b64_tr_b16 v[68:69], v3
    ds_read_b64_tr_b16 v[70:71], v3 offset:1536
    s_waitcnt lgkmcnt(6)
    v_mfma_f32_32x32x16_bf16 v[24:39], v[56:59], v[16:19], v[24:39]
    ds_read_b64_tr_b16 v[56:57], v3 offset:64
    ds_read_b64_tr_b16 v[58:59], v3 offset:1600
    s_waitcnt lgkmcnt(6)
    v_mfma_f32_32x32x16_bf16 v[40:55], v[60:63], v[16:19], v[40:55]
    ds_read_b64_tr_b16 v[60:61], v3 offset:128
    ds_read_b64_tr_b16 v[62:63], v3 offset:1664
    s_waitcnt lgkmcnt(6)
    v_mfma_f32_32x32x16_bf16 v[160:175], v[64:67], v[16:19], v[160:175]
    ds_read_b64_tr_b16 v[64:65], v3 offset:3072
    ds_read_b64_tr_b16 v[66:67], v3 offset:4608
    s_waitcnt lgkmcnt(6)
    v_mfma_f32_32x32x16_bf16 v[24:39], v[68:71], v[72:75], v[24:39]
    ds_read_b64_tr_b16 v[68:69], v3 offset:6144
    ds_read_b64_tr_b16 v[70:71], v3 offset:7680
    s_waitcnt lgkmcnt(6)
    v_mfma_f32_32x32x16_bf16 v[40:55], v[56:59], v[72:75], v[40:55]
    ds_read_b64_tr_b16 v[56:57], v3 offset:3136
    ds_read_b64_tr_b16 v[58:59], v3 offset:4672
    s_waitcnt lgkmcnt(6)
    v_mfma_f32_32x32x16_bf16 v[160:175], v[60:63], v[72:75], v[160:175]
    ds_read_b64_tr_b16 v[60:61], v3 offset:6208
    ds_read_b64_tr_b16 v[62:63], v3 offset:7744
    s_waitcnt lgkmcnt(6)
    v_mfma_f32_32x32x16_bf16 v[24:39], v[64:67], v[76:79], v[24:39]
    ds_read_b64_tr_b16 v[64:65], v3 offset:3200
    ds_read_b64_tr_b16 v[66:67], v3 offset:4736
    s_waitcnt lgkmcnt(6)
    v_mfma_f32_32x32x16_bf16 v[24:39], v[68:71], v[80:83], v[24:39]
    ds_read_b64_tr_b16 v[68:69], v3 offset:6272
    ds_read_b64_tr_b16 v[70:71], v3 offset:7808
    s_waitcnt lgkmcnt(6)
    v_mfma_f32_32x32x16_bf16 v[40:55], v[56:59], v[76:79], v[40:55]
    s_nop 7
    v_cvt_pk_bf16_f32 v24, v24, v25
    s_waitcnt lgkmcnt(4)
    v_mfma_f32_32x32x16_bf16 v[40:55], v[60:63], v[80:83], v[40:55]
    v_cvt_pk_bf16_f32 v25, v26, v27
    v_cvt_pk_bf16_f32 v26, v28, v29
    v_cvt_pk_bf16_f32 v27, v30, v31
    v_cvt_pk_bf16_f32 v28, v32, v33
    v_cvt_pk_bf16_f32 v29, v34, v35
    v_cvt_pk_bf16_f32 v30, v36, v37
    v_cvt_pk_bf16_f32 v31, v38, v39
    v_permlane16_swap_b32 v24, v28
    v_permlane16_swap_b32 v25, v29
    s_waitcnt lgkmcnt(2)
    v_mfma_f32_32x32x16_bf16 v[160:175], v[64:67], v[76:79], v[160:175]
    s_setprio 0
    v_cvt_pk_bf16_f32 v40, v40, v41
    v_cvt_pk_bf16_f32 v41, v42, v43
    v_cvt_pk_bf16_f32 v42, v44, v45
    v_cvt_pk_bf16_f32 v43, v46, v47
    v_cvt_pk_bf16_f32 v44, v48, v49
    s_setprio 2
    s_waitcnt lgkmcnt(0)
    v_mfma_f32_32x32x16_bf16 v[160:175], v[68:71], v[80:83], v[160:175]
    s_setprio 0
    v_cvt_pk_bf16_f32 v45, v50, v51
    v_cvt_pk_bf16_f32 v46, v52, v53
    v_cvt_pk_bf16_f32 v47, v54, v55
    v_permlane16_swap_b32 v26, v30
    v_permlane16_swap_b32 v27, v31
    v_permlane16_swap_b32 v40, v44
    v_permlane16_swap_b32 v41, v45
    s_nop 3
    v_cvt_pk_bf16_f32 v160, v160, v161
    v_cvt_pk_bf16_f32 v161, v162, v163
    v_cvt_pk_bf16_f32 v162, v164, v165
    v_cvt_pk_bf16_f32 v163, v166, v167
    v_cvt_pk_bf16_f32 v164, v168, v169
    v_cvt_pk_bf16_f32 v165, v170, v171
    v_cvt_pk_bf16_f32 v166, v172, v173
    v_cvt_pk_bf16_f32 v167, v174, v175
    v_permlane16_swap_b32 v42, v46
    v_permlane16_swap_b32 v43, v47
    v_permlane16_swap_b32 v160, v164
    v_permlane16_swap_b32 v161, v165
    v_permlane16_swap_b32 v162, v166
    v_permlane16_swap_b32 v163, v167
    buffer_store_dwordx4 v[24:27], v0, s[44:47], 0 offen sc1
    buffer_store_dwordx4 v[28:31], v22, s[44:47], 0 offen sc1
    buffer_store_dwordx4 v[40:43], v0, s[44:47], 0 offen offset:64 sc1
    buffer_store_dwordx4 v[44:47], v22, s[44:47], 0 offen offset:64 sc1
    buffer_store_dwordx4 v[160:163], v0, s[44:47], 0 offen offset:128 sc1
    buffer_store_dwordx4 v[164:167], v22, s[44:47], 0 offen offset:128 sc1
    s_endpgm
L_t1:
    s_branch L_tr
L_body1:
    s_setprio 1
    ds_read_b128 v[8:11], v224
    ds_read_b64_tr_b16 v[64:65], v2 offset:448
    ds_read_b64_tr_b16 v[66:67], v2 offset:1984
    ds_read_b128 v[12:15], v224 offset:32
    ds_read_b64_tr_b16 v[68:69], v2 offset:6592
    ds_read_b64_tr_b16 v[70:71], v2 offset:8128
    s_mov_b64 exec, s[36:37]
    ds_read_b128 v[32:35], v225
    ds_read_b128 v[36:39], v225 offset:32
    s_mov_b64 exec, -1
    ds_read_b64_tr_b16 v[56:57], v1 offset:256
    ds_read_b64_tr_b16 v[58:59], v1 offset:1792
    ds_read_b64_tr_b16 v[60:61], v1 offset:6400
    ds_read_b64_tr_b16 v[62:63], v1 offset:7936
    s_mov_b64 exec, s[36:37]
    ds_read_b128 v[40:43], v225 offset:64
    ds_read_b128 v[44:47], v225 offset:96
    s_mov_b64 exec, -1
    s_mov_b64 exec, s[36:37]
    ds_read_b128 v[48:51], v225 offset:128
    ds_read_b128 v[52:55], v225 offset:160
    s_mov_b64 exec, -1
    ds_read_b128 v[16:19], v224 offset:64
    ds_read_b128 v[20:23], v224 offset:96
    ds_read_b128 v[24:27], v224 offset:128
    ds_read_b128 v[28:31], v224 offset:160
    s_setprio 3
    s_waitcnt lgkmcnt(15)
    v_mfma_f32_32x32x16_bf16 v[192:207], v[64:67], v[8:11], 0
    s_waitcnt lgkmcnt(14)
    v_mfma_f32_32x32x16_bf16 v[192:207], v[68:71], v[12:15], v[192:207]
    s_cmp_eq_u32 s50, 0
    s_cbranch_scc0 L_c12
    s_mov_b32 exec_hi, 0xffff
    s_add_u32 m0, s27, 40064
    s_add_u32 s29, s26, 9216
    buffer_load_dwordx4 v72, s[64:67], s29 offen lds
    s_add_u32 m0, s27, 40832
    s_add_u32 s29, s26, 11520
    buffer_load_dwordx4 v72, s[64:67], s29 offen lds
    s_mov_b32 exec_hi, -1
L_c12:
    s_setprio 2
    s_waitcnt lgkmcnt(10)
    v_mfma_f32_32x32x16_bf16 v[160:175], v[56:59], v[8:11], 0
    ds_read_b32 v158, v141
    v_mfma_f32_32x32x16_bf16 v[176:191], v[56:59], v[32:35], 0
    ds_read_b64_tr_b16 v[56:57], v111 offset:192
    ds_read_b64_tr_b16 v[58:59], v111 offset:1728
    s_cmp_eq_u32 s50, 0
    s_cbranch_scc0 L_c10
    s_mov_b32 exec_hi, 0xffff
    s_add_u32 m0, s27, 36992
    s_add_u32 s29, s26, 0
    buffer_load_dwordx4 v72, s[64:67], s29 offen lds
    s_add_u32 m0, s27, 37760
    s_add_u32 s29, s26, 2304
    buffer_load_dwordx4 v72, s[64:67], s29 offen lds
    s_mov_b32 exec_hi, -1
L_c10:
    s_waitcnt lgkmcnt(11)
    v_mfma_f32_32x32x16_bf16 v[160:175], v[60:63], v[12:15], v[160:175]
    v_mfma_f32_32x32x16_bf16 v[176:191], v[60:63], v[36:39], v[176:191]
    ds_read_b64_tr_b16 v[60:61], v111 offset:6336
    ds_read_b64_tr_b16 v[62:63], v111 offset:7872
    s_waitcnt lgkmcnt(4)
    v_cmp_gt_u32 vcc, 2, v158
    s_cbranch_vccnz L_w11
L_b11:
    v_mfma_f32_32x32x16_bf16 v[208:223], v[64:67], v[32:35], 0
    ds_read_b64_tr_b16 v[64:65], v1 offset:12544
    ds_read_b64_tr_b16 v[66:67], v1 offset:14080
    s_cmp_eq_u32 s50, 0
    s_cbranch_scc0 L_c11
    s_mov_b32 exec_hi, 0xffff
    s_add_u32 m0, s27, 38528
    s_add_u32 s29, s26, 4608
    buffer_load_dwordx4 v72, s[64:67], s29 offen lds
    s_add_u32 m0, s27, 39296
    s_add_u32 s29, s26, 6912
    buffer_load_dwordx4 v72, s[64:67], s29 offen lds
    s_mov_b32 exec_hi, -1
L_c11:
    s_waitcnt lgkmcnt(4)
    v_mfma_f32_32x32x16_bf16 v[224:239], v[56:59], v[8:11], 0
    v_mfma_f32_32x32x16_bf16 v[240:255], v[56:59], v[32:35], 0
    ds_read_b64_tr_b16 v[56:57], v2 offset:12736
    ds_read_b64_tr_b16 v[58:59], v2 offset:14272
    v_mfma_f32_32x32x16_bf16 v[208:223], v[68:71], v[36:39], v[208:223]
    ds_read_b64_tr_b16 v[68:69], v1 offset:18688
    ds_read_b64_tr_b16 v[70:71], v1 offset:20224
    s_waitcnt lgkmcnt(6)
    v_mfma_f32_32x32x16_bf16 v[224:239], v[60:63], v[12:15], v[224:239]
    v_mfma_f32_32x32x16_bf16 v[240:255], v[60:63], v[36:39], v[240:255]
    ds_read_b64_tr_b16 v[60:61], v2 offset:18880
    ds_read_b64_tr_b16 v[62:63], v2 offset:20416
    s_waitcnt lgkmcnt(6)
    v_mfma_f32_32x32x16_bf16 v[160:175], v[64:67], v[16:19], v[160:175]
    s_waitcnt lgkmcnt(4)
    v_mfma_f32_32x32x16_bf16 v[192:207], v[56:59], v[16:19], v[192:207]
    v_mfma_f32_32x32x16_bf16 v[176:191], v[64:67], v[40:43], v[176:191]
    ds_read_b64_tr_b16 v[64:65], v111 offset:12480
    ds_read_b64_tr_b16 v[66:67], v111 offset:14016
    v_mfma_f32_32x32x16_bf16 v[208:223], v[56:59], v[40:43], v[208:223]
    s_waitcnt lgkmcnt(2)
    v_mfma_f32_32x32x16_bf16 v[192:207], v[60:63], v[20:23], v[192:207]
    v_mfma_f32_32x32x16_bf16 v[160:175], v[68:71], v[20:23], v[160:175]
    ds_read_b32 v158, v141
    v_mfma_f32_32x32x16_bf16 v[176:191], v[68:71], v[44:47], v[176:191]
    ds_read_b64_tr_b16 v[68:69], v111 offset:18624
    ds_read_b64_tr_b16 v[70:71], v111 offset:20160
    v_mfma_f32_32x32x16_bf16 v[208:223], v[60:63], v[44:47], v[208:223]
    s_waitcnt lgkmcnt(3)
    v_mfma_f32_32x32x16_bf16 v[224:239], v[64:67], v[16:19], v[224:239]
    v_mfma_f32_32x32x16_bf16 v[240:255], v[64:67], v[40:43], v[240:255]
    s_waitcnt lgkmcnt(2)
    v_cmp_gt_u32 vcc, 3, v158
    s_cbranch_vccnz L_w21
L_b21:
    ds_read_b64_tr_b16 v[56:57], v1 offset:24832
    ds_read_b64_tr_b16 v[58:59], v1 offset:26368
    s_waitcnt lgkmcnt(2)
    v_mfma_f32_32x32x16_bf16 v[224:239], v[68:71], v[20:23], v[224:239]
    ds_read_b64_tr_b16 v[60:61], v1 offset:30976
    ds_read_b64_tr_b16 v[62:63], v1 offset:32512
    ds_read_b64_tr_b16 v[64:65], v2 offset:25024
    ds_read_b64_tr_b16 v[66:67], v2 offset:26560
    v_mfma_f32_32x32x16_bf16 v[240:255], v[68:71], v[44:47], v[240:255]
    ds_read_b64_tr_b16 v[68:69], v2 offset:31168
    ds_read_b64_tr_b16 v[70:71], v2 offset:32704
    s_waitcnt vmcnt(0)
    s_mov_b64 exec, s[24:25]
    ds_write_b8 v141, v127
    s_mov_b64 exec, -1
    s_waitcnt lgkmcnt(7)
    v_mfma_f32_32x32x16_bf16 v[160:175], v[56:59], v[24:27], v[160:175]
    s_waitcnt lgkmcnt(5)
    v_mfma_f32_32x32x16_bf16 v[160:175], v[60:63], v[28:31], v[160:175]
    v_mfma_f32_32x32x16_bf16 v[176:191], v[56:59], v[48:51], v[176:191]
    ds_read_b64_tr_b16 v[56:57], v111 offset:24768
    ds_read_b64_tr_b16 v[58:59], v111 offset:26304
    ds_read_b32 v158, v141
    v_mfma_f32_32x32x16_bf16 v[176:191], v[60:63], v[52:55], v[176:191]
    ds_read_b64_tr_b16 v[60:61], v111 offset:30912
    ds_read_b64_tr_b16 v[62:63], v111 offset:32448
    s_nop 4
    v_mul_f32 v160, s4, v160
    v_mul_f32 v161, s4, v161
    v_mul_f32 v162, s4, v162
    s_waitcnt lgkmcnt(8)
    v_mfma_f32_32x32x16_bf16 v[192:207], v[64:67], v[24:27], v[192:207]
    v_mul_f32 v163, s4, v163
    v_mul_f32 v164, s4, v164
    v_mul_f32 v165, s4, v165
    v_mul_f32 v166, s4, v166
    v_mul_f32 v167, s4, v167
    v_mfma_f32_32x32x16_bf16 v[208:223], v[64:67], v[48:51], v[208:223]
    v_mul_f32 v168, s4, v168
    v_mul_f32 v169, s4, v169
    v_mul_f32 v170, s4, v170
    v_mul_f32 v171, s4, v171
    v_mul_f32 v172, s4, v172
    s_waitcnt lgkmcnt(5)
    v_mfma_f32_32x32x16_bf16 v[192:207], v[68:71], v[28:31], v[192:207]
    v_mul_f32 v173, s4, v173
    v_mul_f32 v174, s4, v174
    v_mul_f32 v175, s4, v175
    v_mul_f32 v176, s4, v176
    v_mul_f32 v177, s4, v177
    v_mfma_f32_32x32x16_bf16 v[208:223], v[68:71], v[52:55], v[208:223]
    s_waitcnt lgkmcnt(0)
    v_cmp_gt_u32 vcc, 4, v158
    s_cbranch_vccnz L_w31
L_b31:
    v_mul_f32 v178, s4, v178
    ds_read_b64_tr_b16 v[64:65], v7 offset:96
    ds_read_b64_tr_b16 v[66:67], v7 offset:864
    ds_read_b64_tr_b16 v[68:69], v7 offset:3168
    v_mfma_f32_32x32x16_bf16 v[224:239], v[56:59], v[24:27], v[224:239]
    ds_read_b64_tr_b16 v[70:71], v7 offset:3936
    v_mul_f32 v179, s4, v179
    v_mul_f32 v180, s4, v180
    v_mul_f32 v181, s4, v181
    v_mul_f32 v182, s4, v182
    v_mfma_f32_32x32x16_bf16 v[240:255], v[56:59], v[48:51], v[240:255]
    ds_read_b64_tr_b16 v[56:57], v7 offset:6240
    ds_read_b64_tr_b16 v[58:59], v7 offset:7008
    v_mul_f32 v183, s4, v183
    v_mul_f32 v184, s4, v184
    v_mul_f32 v185, s4, v185
    v_mfma_f32_32x32x16_bf16 v[224:239], v[60:63], v[28:31], v[224:239]
    v_mul_f32 v186, s4, v186
    v_mul_f32 v187, s4, v187
    v_mul_f32 v188, s4, v188
    v_mul_f32 v189, s4, v189
    v_mul_f32 v190, s4, v190
    v_mfma_f32_32x32x16_bf16 v[240:255], v[60:63], v[52:55], v[240:255]
    ds_read_b64_tr_b16 v[60:61], v7 offset:9312
    ds_read_b64_tr_b16 v[62:63], v7 offset:10080
    v_mul_f32 v191, s4, v191
    v_cvt_pk_bf16_f32 v76, v160, v161
    v_cvt_pk_bf16_f32 v77, v162, v163
    v_cvt_pk_bf16_f32 v80, v164, v165
    v_cvt_pk_bf16_f32 v81, v166, v167
    v_cvt_pk_bf16_f32 v82, v168, v169
    v_cvt_pk_bf16_f32 v83, v170, v171
    v_cvt_pk_bf16_f32 v84, v172, v173
    v_cvt_pk_bf16_f32 v85, v174, v175
    s_waitcnt lgkmcnt(5)
    v_mfma_f32_32x32x16_bf16 v[160:175], v[8:11], v[64:67], 0
    v_cvt_pk_bf16_f32 v90, v176, v177
    s_setprio 1
    v_cvt_pk_bf16_f32 v91, v178, v179
    v_cvt_pk_bf16_f32 v94, v180, v181
    v_cvt_pk_bf16_f32 v95, v182, v183
    v_cvt_pk_bf16_f32 v96, v184, v185
    s_waitcnt lgkmcnt(2)
    v_mfma_f32_32x32x16_bf16 v[160:175], v[12:15], v[68:71], v[160:175]
    v_cvt_pk_bf16_f32 v97, v186, v187
    v_cvt_pk_bf16_f32 v98, v188, v189
    v_cvt_pk_bf16_f32 v99, v190, v191
    s_cmp_eq_u32 s50, 0
    s_cbranch_scc0 L_c13
    s_add_u32 m0, s28, 55424
    s_add_u32 s29, s28, 0
    buffer_load_dwordx4 v73, s[40:43], s29 offen lds
    s_add_u32 m0, s28, 59520
    s_add_u32 s29, s28, 4096
    buffer_load_dwordx4 v73, s[40:43], s29 offen lds
L_c13:
    v_mfma_f32_32x32x16_bf16 v[176:191], v[32:35], v[64:67], 0
    ds_read_b64_tr_b16 v[64:65], v7 offset:12384
    ds_read_b64_tr_b16 v[66:67], v7 offset:13152
    s_cmp_eq_u32 s50, 0
    s_cbranch_scc0 L_c14
    s_add_u32 m0, s28, 63616
    s_add_u32 s29, s28, 8192
    buffer_load_dwordx4 v73, s[40:43], s29 offen lds
    s_add_u32 m0, s28, 67712
    s_add_u32 s29, s28, 12288
    buffer_load_dwordx4 v73, s[40:43], s29 offen lds
L_c14:
    v_mfma_f32_32x32x16_bf16 v[176:191], v[36:39], v[68:71], v[176:191]
    ds_read_b64_tr_b16 v[68:69], v7 offset:15456
    ds_read_b64_tr_b16 v[70:71], v7 offset:16224
    s_cmp_eq_u32 s50, 0
    s_cbranch_scc0 L_c15
    s_add_u32 s29, s28, 16384
    s_min_u32 s29, s29, 17408
    s_add_u32 m0, s29, 55424
    s_nop 0
    buffer_load_dwordx4 v73, s[40:43], s29 offen lds
L_c15:
    v_mfma_f32_32x32x16_bf16 v[160:175], v[16:19], v[56:59], v[160:175]
    v_mul_f32 v224, s4, v224
    v_mul_f32 v225, s4, v225
    v_mul_f32 v226, s4, v226
    v_mul_f32 v227, s4, v227
    v_mul_f32 v228, s4, v228
    v_mfma_f32_32x32x16_bf16 v[176:191], v[40:43], v[56:59], v[176:191]
    ds_read_b64_tr_b16 v[56:57], v7 offset:144
    ds_read_b64_tr_b16 v[58:59], v7 offset:912
    v_mul_f32 v229, s4, v229
    v_mul_f32 v230, s4, v230
    v_mul_f32 v231, s4, v231
    s_waitcnt lgkmcnt(6)
    v_mfma_f32_32x32x16_bf16 v[160:175], v[20:23], v[60:63], v[160:175]
    v_cvt_pk_bf16_f32 v72, v224, v225
    v_cvt_pk_bf16_f32 v73, v226, v227
    v_cvt_pk_bf16_f32 v74, v228, v229
    v_cvt_pk_bf16_f32 v75, v230, v231
    v_cvt_pk_bf16_f32 v100, v232, v233
    v_mfma_f32_32x32x16_bf16 v[176:191], v[44:47], v[60:63], v[176:191]
    ds_read_b64_tr_b16 v[60:61], v7 offset:3216
    ds_read_b64_tr_b16 v[62:63], v7 offset:3984
    v_cvt_pk_bf16_f32 v101, v234, v235
    v_cvt_pk_bf16_f32 v102, v236, v237
    v_cvt_pk_bf16_f32 v103, v238, v239
    s_waitcnt lgkmcnt(6)
    v_mfma_f32_32x32x16_bf16 v[160:175], v[24:27], v[64:67], v[160:175]
    ds_read_b128 v[224:227], v4
    ds_read_b128 v[228:231], v4 offset:128
    ds_read_b128 v[232:235], v4 offset:256
    ds_read_b96 v[236:238], v4 offset:16
    ds_read_b32 v239, v6 offset:384
    v_mul_f32 v240, s4, v240
    v_mfma_f32_32x32x16_bf16 v[176:191], v[48:51], v[64:67], v[176:191]
    ds_read_b64_tr_b16 v[64:65], v7 offset:6288
    ds_read_b64_tr_b16 v[66:67], v7 offset:7056
    v_mul_f32 v241, s4, v241
    v_mul_f32 v242, s4, v242
    v_mul_f32 v243, s4, v243
    s_waitcnt lgkmcnt(9)
    v_mfma_f32_32x32x16_bf16 v[160:175], v[28:31], v[68:71], v[160:175]
    v_mul_f32 v244, s4, v244
    v_mul_f32 v245, s4, v245
    v_mul_f32 v246, s4, v246
    v_mul_f32 v247, s4, v247
    v_cvt_pk_bf16_f32 v104, v192, v193
    v_mfma_f32_32x32x16_bf16 v[176:191], v[52:55], v[68:71], v[176:191]
    ds_read_b64_tr_b16 v[68:69], v7 offset:9360
    ds_read_b64_tr_b16 v[70:71], v7 offset:10128
    v_cvt_pk_bf16_f32 v105, v194, v195
    v_cvt_pk_bf16_f32 v108, v196, v197
    v_cvt_pk_bf16_f32 v109, v198, v199
    s_mov_b64 exec, s[60:61]
    v_cvt_pk_bf16_f32 v128, v160, v161
    v_cvt_pk_bf16_f32 v129, v162, v163
    v_cvt_pk_bf16_f32 v130, v164, v165
    v_cvt_pk_bf16_f32 v131, v166, v167
    v_cvt_pk_bf16_f32 v132, v168, v169
    v_cvt_pk_bf16_f32 v133, v170, v171
    v_cvt_pk_bf16_f32 v134, v172, v173
    v_cvt_pk_bf16_f32 v135, v174, v175
    s_mov_b64 exec, -1
    s_waitcnt lgkmcnt(4)
    v_mfma_f32_32x32x16_bf16 v[224:239], v[100:103], v[72:75], v[224:239]
    v_cvt_pk_bf16_f32 v110, v200, v201
    v_cvt_pk_bf16_f32 v111, v202, v203
    v_cvt_pk_bf16_f32 v112, v204, v205
    v_cvt_pk_bf16_f32 v113, v206, v207
    v_cvt_pk_bf16_f32 v118, v208, v209
    v_mfma_f32_32x32x16_bf16 v[192:207], v[8:11], v[56:59], 0
    v_cvt_pk_bf16_f32 v119, v210, v211
    v_cvt_pk_bf16_f32 v122, v212, v213
    v_cvt_pk_bf16_f32 v123, v214, v215
    v_cvt_pk_bf16_f32 v124, v216, v217
    v_cvt_pk_bf16_f32 v125, v218, v219
    v_mfma_f32_32x32x16_bf16 v[192:207], v[12:15], v[60:63], v[192:207]
    v_cvt_pk_bf16_f32 v126, v220, v221
    v_cvt_pk_bf16_f32 v127, v222, v223
    v_cvt_pk_bf16_f32 v86, v240, v241
    v_cvt_pk_bf16_f32 v87, v242, v243
    v_cvt_pk_bf16_f32 v88, v244, v245
    v_mfma_f32_32x32x16_bf16 v[208:223], v[32:35], v[56:59], 0
    v_cvt_pk_bf16_f32 v89, v246, v247
    v_cvt_pk_bf16_f32 v114, v248, v249
    ds_read_b96 v[240:242], v4 offset:144
    ds_read_b32 v243, v6 offset:392
    ds_read_b96 v[244:246], v4 offset:272
    s_waitcnt lgkmcnt(3)
    v_mfma_f32_32x32x16_bf16 v[192:207], v[16:19], v[64:67], v[192:207]
    ds_read_b32 v247, v6 offset:400
    ds_read_b32 v248, v143 offset:408
    s_mov_b64 exec, s[60:61]
    v_cvt_pk_bf16_f32 v136, v176, v177
    v_cvt_pk_bf16_f32 v137, v178, v179
    v_cvt_pk_bf16_f32 v138, v180, v181
    v_cvt_pk_bf16_f32 v139, v182, v183
    v_cvt_pk_bf16_f32 v140, v184, v185
    s_mov_b64 exec, -1
    v_mfma_f32_32x32x16_bf16 v[208:223], v[36:39], v[60:63], v[208:223]
    ds_read_b64_tr_b16 v[56:57], v7 offset:12432
    ds_read_b64_tr_b16 v[58:59], v7 offset:13200
    ds_read_b128 v[160:163], v4 offset:3392
    ds_read_b128 v[164:167], v4 offset:3520
    ds_read_b128 v[168:171], v4 offset:3648
    ds_read_b96 v[172:174], v4 offset:3408
    v_mfma_f32_32x32x16_bf16 v[192:207], v[20:23], v[68:71], v[192:207]
    ds_read_b32 v175, v6 offset:3776
    ds_read_b96 v[176:178], v4 offset:3536
    ds_read_b32 v179, v6 offset:3784
    ds_read_b96 v[180:182], v4 offset:3664
    ds_read_b32 v183, v6 offset:3792
    ds_read_b32 v184, v143 offset:3800
    v_mfma_f32_32x32x16_bf16 v[224:239], v[104:107], v[76:79], v[224:239]
    ds_read_b64_tr_b16 v[60:61], v7 offset:15504
    ds_read_b64_tr_b16 v[62:63], v7 offset:16272
    v_cvt_pk_bf16_f32 v115, v250, v251
    v_cvt_pk_bf16_f32 v116, v252, v253
    v_cvt_pk_bf16_f32 v117, v254, v255
    v_mfma_f32_32x32x16_bf16 v[208:223], v[40:43], v[64:67], v[208:223]
    v_lshrrev_b32 v20, 20, v157
    v_add_u32 v22, 32, v0
    v_add_u32 v20, s72, v20
    s_nop 0
    v_permlane16_swap_b32 v0, v22
    s_waitcnt lgkmcnt(14)
    v_mfma_f32_32x32x16_bf16 v[240:255], v[114:117], v[72:75], v[240:255]
    v_exp_f32 v224, v224
    v_exp_f32 v225, v225
    v_exp_f32 v226, v226
    s_waitcnt lgkmcnt(12)
    v_mfma_f32_32x32x16_bf16 v[192:207], v[24:27], v[56:59], v[192:207]
    v_exp_f32 v227, v227
    v_exp_f32 v228, v228
    v_exp_f32 v229, v229
    s_waitcnt lgkmcnt(7)
    v_mfma_f32_32x32x16_bf16 v[160:175], v[106:109], v[78:81], v[160:175]
    v_exp_f32 v230, v230
    v_exp_f32 v231, v231
    v_exp_f32 v232, v232
    s_waitcnt lgkmcnt(2)
    v_mfma_f32_32x32x16_bf16 v[176:191], v[120:123], v[78:81], v[176:191]
    v_exp_f32 v233, v233
    v_exp_f32 v234, v234
    v_exp_f32 v235, v235
    v_mfma_f32_32x32x16_bf16 v[240:255], v[118:121], v[76:79], v[240:255]
    v_exp_f32 v236, v236
    v_exp_f32 v237, v237
    v_cvt_pk_bf16_f32 v224, v224, v225
    s_waitcnt lgkmcnt(0)
    v_mfma_f32_32x32x16_bf16 v[192:207], v[28:31], v[60:63], v[192:207]
    v_cvt_pk_bf16_f32 v225, v226, v227
    v_cvt_pk_bf16_f32 v226, v228, v229
    v_cvt_pk_bf16_f32 v227, v230, v231
    v_cvt_pk_bf16_f32 v228, v232, v233
    s_nop 2
    v_exp_f32 v240, v240
    v_mfma_f32_32x32x16_bf16 v[160:175], v[110:113], v[82:85], v[160:175]
    v_exp_f32 v241, v241
    v_exp_f32 v242, v242
    v_exp_f32 v243, v243
    v_mfma_f32_32x32x16_bf16 v[208:223], v[44:47], v[68:71], v[208:223]
    v_exp_f32 v244, v244
    v_exp_f32 v245, v245
    v_exp_f32 v246, v246
    v_mfma_f32_32x32x16_bf16 v[176:191], v[124:127], v[82:85], v[176:191]
    v_exp_f32 v247, v247
    v_exp_f32 v248, v248
    s_mov_b64 exec, s[60:61]
    v_cvt_pk_bf16_f32 v144, v192, v193
    v_cvt_pk_bf16_f32 v145, v194, v195
    v_cvt_pk_bf16_f32 v146, v196, v197
    v_cvt_pk_bf16_f32 v147, v198, v199
    v_cvt_pk_bf16_f32 v148, v200, v201
    v_cvt_pk_bf16_f32 v149, v202, v203
    v_cvt_pk_bf16_f32 v150, v204, v205
    v_cvt_pk_bf16_f32 v151, v206, v207
    s_mov_b64 exec, -1
    v_mfma_f32_32x32x16_bf16 v[208:223], v[48:51], v[56:59], v[208:223]
    v_cvt_pk_bf16_f32 v229, v234, v235
    v_cvt_pk_bf16_f32 v230, v236, v237
    v_exp_f32 v160, v160
    s_setprio 0
    v_exp_f32 v161, v161
    s_setprio 2
    v_mfma_f32_32x32x16_bf16 v[208:223], v[52:55], v[60:63], v[208:223]
    s_setprio 0
    v_cvt_pk_bf16_f32 v232, v240, v241
    v_cvt_pk_bf16_f32 v233, v242, v243
    v_cvt_pk_bf16_f32 v234, v244, v245
    v_cvt_pk_bf16_f32 v235, v246, v247
    v_cvt_pk_bf16_f32 v236, v248, 0
    s_setprio 2
    v_mfma_f32_32x32x16_bf16 v[240:255], v[128:131], v[224:227], 0
    s_setprio 0
    v_exp_f32 v162, v162
    v_exp_f32 v163, v163
    v_exp_f32 v164, v164
    v_exp_f32 v165, v165
    v_exp_f32 v166, v166
    v_exp_f32 v167, v167
    v_exp_f32 v168, v168
    v_exp_f32 v169, v169
    v_exp_f32 v170, v170
    v_exp_f32 v171, v171
    v_exp_f32 v172, v172
    v_exp_f32 v173, v173
    v_cvt_pk_bf16_f32 v160, v160, v161
    v_exp_f32 v238, v238
    v_exp_f32 v239, v239
    v_exp_f32 v176, v176
    v_exp_f32 v177, v177
    v_exp_f32 v178, v178
    v_exp_f32 v179, v179
    v_exp_f32 v180, v180
    v_exp_f32 v181, v181
    v_exp_f32 v182, v182
    v_exp_f32 v183, v183
    v_exp_f32 v184, v184
    v_cvt_pk_bf16_f32 v161, v162, v163
    v_cvt_pk_bf16_f32 v162, v164, v165
    v_cvt_pk_bf16_f32 v163, v166, v167
    v_cvt_pk_bf16_f32 v164, v168, v169
    v_cvt_pk_bf16_f32 v165, v170, v171
    v_cvt_pk_bf16_f32 v166, v172, v173
    v_cvt_pk_bf16_f32 v231, v238, v239
    v_cvt_pk_bf16_f32 v168, v176, v177
    v_cvt_pk_bf16_f32 v169, v178, v179
    s_setprio 2
    v_mfma_f32_32x32x16_bf16 v[240:255], v[132:135], v[228:231], v[240:255]
    s_setprio 0
    v_cvt_pk_bf16_f32 v170, v180, v181
    s_setprio 1
    v_cvt_pk_bf16_f32 v171, v182, v183
    v_cvt_pk_bf16_f32 v172, v184, 0
    v_exp_f32 v174, v174
    v_mfma_f32_32x32x16_bf16 v[176:191], v[144:147], v[160:163], 0
    v_exp_f32 v175, v175
    s_mov_b64 exec, s[60:61]
    v_cvt_pk_bf16_f32 v152, v208, v209
    v_cvt_pk_bf16_f32 v153, v210, v211
    v_cvt_pk_bf16_f32 v154, v212, v213
    v_cvt_pk_bf16_f32 v155, v214, v215
    v_cvt_pk_bf16_f32 v156, v216, v217
    s_mov_b64 exec, -1
    v_mfma_f32_32x32x16_bf16 v[240:255], v[136:139], v[232:235], v[240:255]
    v_cvt_pk_bf16_f32 v167, v174, v175
    v_mov_b32 v237, 0
    v_mov_b32 v173, 0
    ds_read_b128 v[192:195], v5
    ds_read_b128 v[196:199], v5 offset:128
    v_mfma_f32_32x32x16_bf16 v[176:191], v[148:151], v[164:167], v[176:191]
    ds_read_b128 v[200:203], v5 offset:256
    ds_read_b96 v[204:206], v5 offset:16
    ds_read_b32 v207, v142 offset:384
    ds_read_b96 v[208:210], v5 offset:144
    ds_read_b32 v211, v142 offset:392
    ds_read_b96 v[212:214], v5 offset:272
    v_mfma_f32_32x32x16_bf16 v[176:191], v[152:155], v[168:171], v[176:191]
    ds_read_b32 v215, v142 offset:400
    ds_read_b32 v216, v159 offset:408
    v_mfma_f32_32x32x8bf16_1k v[240:255], v[140:141], v[236:237], v[240:255]
    v_mfma_f32_32x32x8bf16_1k v[176:191], v[156:157], v[172:173], v[176:191]
    s_nop 10
    v_rcp_f32 v253, v252
    v_subrev_u32 v254, s5, v252
    v_cmp_lt_u32 vcc, s11, v254
    v_mul_f32 v240, v253, v240
    v_mul_f32 v241, v253, v241
    s_cbranch_vccnz L_r100
L_q100:
    v_mul_f32 v242, v253, v242
    v_mul_f32 v243, v253, v243
    s_waitcnt lgkmcnt(5)
    v_mfma_f32_32x32x16_bf16 v[192:207], v[100:103], v[86:89], v[192:207]
    v_rcp_f32 v189, v188
    v_subrev_u32 v190, s5, v188
    v_cmp_lt_u32 vcc, s11, v190
    v_mul_f32 v176, v189, v176
    v_mul_f32 v177, v189, v177
    s_cbranch_vccnz L_r110
L_q110:
    s_waitcnt lgkmcnt(0)
    v_mfma_f32_32x32x16_bf16 v[208:223], v[114:117], v[86:89], v[208:223]
    v_mul_f32 v244, v253, v244
    v_mul_f32 v245, v253, v245
    v_mul_f32 v246, v253, v246
    v_mul_f32 v247, v253, v247
    v_mul_f32 v248, v253, v248
    s_setprio 2
    v_mfma_f32_32x32x16_bf16 v[192:207], v[104:107], v[90:93], v[192:207]
    s_setprio 0
    v_mul_f32 v249, v253, v249
    v_mul_f32 v250, v253, v250
    v_mul_f32 v251, v253, v251
    v_cvt_pk_bf16_f32 v72, v240, v241
    v_cvt_pk_bf16_f32 v73, v242, v243
    s_setprio 2
    v_mfma_f32_32x32x16_bf16 v[208:223], v[118:121], v[90:93], v[208:223]
    s_setprio 0
    v_cvt_pk_bf16_f32 v74, v244, v245
    v_cvt_pk_bf16_f32 v75, v246, v247
    v_mul_f32 v178, v189, v178
    v_mul_f32 v179, v189, v179
    v_cvt_pk_bf16_f32 v76, v248, v249
    v_cvt_pk_bf16_f32 v77, v250, v251
    v_mul_f32 v180, v189, v180
    v_mul_f32 v181, v189, v181
    v_mul_f32 v182, v189, v182
    v_mul_f32 v183, v189, v183
    v_mul_f32 v184, v189, v184
    v_mul_f32 v185, v189, v185
    v_mul_f32 v186, v189, v186
    v_mul_f32 v187, v189, v187
    v_cvt_pk_bf16_f32 v78, v176, v177
    v_cvt_pk_bf16_f32 v79, v178, v179
    ds_write_b128 v20, v[72:75] offset:3072
    v_cvt_pk_bf16_f32 v80, v180, v181
    v_cvt_pk_bf16_f32 v81, v182, v183
    v_cvt_pk_bf16_f32 v82, v184, v185
    v_cvt_pk_bf16_f32 v83, v186, v187
    ds_write_b128 v20, v[76:79] offset:4096
    s_waitcnt vmcnt(0)
    s_mov_b64 exec, s[24:25]
    ds_write_b8 v141, v157
    s_mov_b64 exec, -1
    ds_write_b128 v20, v[80:83] offset:5120
    ds_read_b128 v[224:227], v5 offset:3392
    ds_read_b128 v[228:231], v5 offset:3520
    ds_read_b128 v[232:235], v5 offset:3648
    ds_read_b96 v[236:238], v5 offset:3408
    ds_read_b32 v239, v142 offset:3776
    s_mov_b64 exec, s[6:7]
    ds_write_b8_d16_hi v141, v157
    s_mov_b64 exec, -1
    ds_read_b96 v[240:242], v5 offset:3536
    ds_read_b32 v243, v142 offset:3784
    ds_read_b96 v[244:246], v5 offset:3664
    ds_read_b32 v247, v142 offset:3792
    ds_read_b32 v248, v159 offset:3800
    v_exp_f32 v192, v192
    v_exp_f32 v193, v193
    v_exp_f32 v194, v194
    v_exp_f32 v195, v195
    v_exp_f32 v196, v196
    v_exp_f32 v197, v197
    v_exp_f32 v198, v198
    v_exp_f32 v199, v199
    v_exp_f32 v200, v200
    v_exp_f32 v201, v201
    v_exp_f32 v202, v202
    s_setprio 2
    s_waitcnt lgkmcnt(6)
    v_mfma_f32_32x32x16_bf16 v[224:239], v[106:109], v[92:95], v[224:239]
    s_setprio 0
    v_exp_f32 v203, v203
    v_exp_f32 v204, v204
    v_exp_f32 v205, v205
    s_setprio 2
    s_waitcnt lgkmcnt(0)
    v_mfma_f32_32x32x16_bf16 v[240:255], v[120:123], v[92:95], v[240:255]
    s_setprio 0
    v_cvt_pk_bf16_f32 v192, v192, v193
    v_exp_f32 v208, v208
    v_exp_f32 v209, v209
    s_setprio 2
    v_mfma_f32_32x32x16_bf16 v[224:239], v[110:113], v[96:99], v[224:239]
    s_setprio 0
    v_exp_f32 v210, v210
    v_exp_f32 v211, v211
    v_exp_f32 v212, v212
    s_setprio 1
    v_mfma_f32_32x32x16_bf16 v[240:255], v[124:127], v[96:99], v[240:255]
    v_exp_f32 v213, v213
    v_exp_f32 v214, v214
    s_setprio 0
    v_exp_f32 v215, v215
    v_exp_f32 v216, v216
    v_cvt_pk_bf16_f32 v193, v194, v195
    v_cvt_pk_bf16_f32 v194, v196, v197
    v_cvt_pk_bf16_f32 v195, v198, v199
    v_cvt_pk_bf16_f32 v196, v200, v201
    v_cvt_pk_bf16_f32 v197, v202, v203
    v_cvt_pk_bf16_f32 v198, v204, v205
    v_exp_f32 v224, v224
    v_exp_f32 v225, v225
    v_cvt_pk_bf16_f32 v200, v208, v209
    v_cvt_pk_bf16_f32 v201, v210, v211
    v_cvt_pk_bf16_f32 v202, v212, v213
    v_cvt_pk_bf16_f32 v203, v214, v215
    v_cvt_pk_bf16_f32 v204, v216, 0
    s_setprio 2
    v_mfma_f32_32x32x16_bf16 v[208:223], v[128:131], v[192:195], 0
    s_setprio 0
    v_exp_f32 v226, v226
    v_exp_f32 v227, v227
    v_exp_f32 v228, v228
    v_exp_f32 v229, v229
    v_exp_f32 v230, v230
    v_exp_f32 v231, v231
    v_exp_f32 v232, v232
    v_exp_f32 v233, v233
    v_exp_f32 v234, v234
    v_exp_f32 v235, v235
    v_exp_f32 v236, v236
    v_exp_f32 v237, v237
    v_cvt_pk_bf16_f32 v224, v224, v225
    v_exp_f32 v206, v206
    v_exp_f32 v207, v207
    v_exp_f32 v240, v240
    v_exp_f32 v241, v241
    v_exp_f32 v242, v242
    v_exp_f32 v243, v243
    v_exp_f32 v244, v244
    v_exp_f32 v245, v245
    v_exp_f32 v246, v246
    v_exp_f32 v247, v247
    v_exp_f32 v248, v248
    v_cvt_pk_bf16_f32 v225, v226, v227
    v_cvt_pk_bf16_f32 v226, v228, v229
    v_cvt_pk_bf16_f32 v227, v230, v231
    v_cvt_pk_bf16_f32 v228, v232, v233
    v_cvt_pk_bf16_f32 v229, v234, v235
    v_cvt_pk_bf16_f32 v230, v236, v237
    v_cvt_pk_bf16_f32 v199, v206, v207
    v_cvt_pk_bf16_f32 v232, v240, v241
    v_cvt_pk_bf16_f32 v233, v242, v243
    s_setprio 2
    v_mfma_f32_32x32x16_bf16 v[208:223], v[132:135], v[196:199], v[208:223]
    s_setprio 1
    v_cvt_pk_bf16_f32 v234, v244, v245
    v_cvt_pk_bf16_f32 v235, v246, v247
    v_cvt_pk_bf16_f32 v236, v248, 0
    v_exp_f32 v238, v238
    v_mfma_f32_32x32x16_bf16 v[240:255], v[144:147], v[224:227], 0
    v_exp_f32 v239, v239
    ds_read_b32 v21, v141
    ds_read_b128 v[8:11], v20
    ds_read_b128 v[12:15], v20 offset:1024
    ds_read_b128 v[16:19], v20 offset:2048
    v_mfma_f32_32x32x16_bf16 v[208:223], v[136:139], v[200:203], v[208:223]
    v_cvt_pk_bf16_f32 v231, v238, v239
    v_mov_b32 v205, 0
    v_mov_b32 v237, 0
    v_mfma_f32_32x32x16_bf16 v[240:255], v[148:151], v[228:231], v[240:255]
    v_mfma_f32_32x32x16_bf16 v[240:255], v[152:155], v[232:235], v[240:255]
    v_mfma_f32_32x32x8bf16_1k v[208:223], v[140:141], v[204:205], v[208:223]
    v_mfma_f32_32x32x8bf16_1k v[240:255], v[156:157], v[236:237], v[240:255]
    s_setprio 0
    s_nop 9
    v_rcp_f32 v221, v220
    v_subrev_u32 v222, s5, v220
    v_cmp_lt_u32 vcc, s11, v222
    v_mul_f32 v208, v221, v208
    v_mul_f32 v209, v221, v209
    s_cbranch_vccnz L_r101
L_q101:
    v_mul_f32 v210, v221, v210
    v_mul_f32 v211, v221, v211
    v_rcp_f32 v253, v252
    v_subrev_u32 v254, s5, v252
    v_cmp_lt_u32 vcc, s11, v254
    v_mul_f32 v240, v253, v240
    v_mul_f32 v241, v253, v241
    s_cbranch_vccnz L_r111
L_q111:
    s_waitcnt lgkmcnt(0)
    v_cmp_gt_u32 vcc, 7, v21
    v_cmp_gt_u32 s[74:75], 6, v21
    s_and_b32 s70, vcc_lo, s63
    s_or_b32 s70, s70, s74
    s_cbranch_scc1 L_wait1
L_back1:
    ds_read_b64_tr_b16 v[64:65], v3
    ds_read_b64_tr_b16 v[66:67], v3 offset:1536
    ds_read_b64_tr_b16 v[68:69], v3 offset:64
    ds_read_b64_tr_b16 v[70:71], v3 offset:1600
    ds_read_b64_tr_b16 v[56:57], v3 offset:128
    ds_read_b64_tr_b16 v[58:59], v3 offset:1664
    ds_read_b64_tr_b16 v[60:61], v3 offset:3072
    ds_read_b64_tr_b16 v[62:63], v3 offset:4608
    v_mul_f32 v212, v221, v212
    v_mul_f32 v213, v221, v213
    v_mul_f32 v214, v221, v214
    v_mul_f32 v215, v221, v215
    v_cvt_pk_bf16_f32 v86, v208, v209
    v_cvt_pk_bf16_f32 v87, v210, v211
    v_cvt_pk_bf16_f32 v88, v212, v213
    v_cvt_pk_bf16_f32 v89, v214, v215
    v_mul_f32 v216, v221, v216
    v_mul_f32 v217, v221, v217
    v_mul_f32 v218, v221, v218
    v_mul_f32 v219, v221, v219
    v_mul_f32 v242, v253, v242
    v_mul_f32 v243, v253, v243
    v_cvt_pk_bf16_f32 v90, v216, v217
    v_cvt_pk_bf16_f32 v91, v218, v219
    v_cvt_pk_bf16_f32 v92, v240, v241
    v_cvt_pk_bf16_f32 v93, v242, v243
    v_mul_f32 v244, v253, v244
    v_mul_f32 v245, v253, v245
    v_mul_f32 v246, v253, v246
    v_mul_f32 v247, v253, v247
    v_mul_f32 v248, v253, v248
    s_setprio 2
    s_waitcnt lgkmcnt(5)
    v_mfma_f32_32x32x16_bf16 v[24:39], v[64:67], v[8:11], 0
    ds_read_b64_tr_b16 v[64:65], v3 offset:3136
    ds_read_b64_tr_b16 v[66:67], v3 offset:4672
    s_setprio 0
    v_mul_f32 v249, v253, v249
    v_mul_f32 v250, v253, v250
    s_setprio 1
    v_mul_f32 v251, v253, v251
    s_waitcnt lgkmcnt(2)
    v_mfma_f32_32x32x16_bf16 v[40:55], v[68:71], v[8:11], 0
    ds_read_b64_tr_b16 v[68:69], v3 offset:3200
    ds_read_b64_tr_b16 v[70:71], v3 offset:4736
    v_cvt_pk_bf16_f32 v94, v244, v245
    v_cvt_pk_bf16_f32 v95, v246, v247
    v_cvt_pk_bf16_f32 v96, v248, v249
    v_mfma_f32_32x32x16_bf16 v[160:175], v[56:59], v[8:11], 0
    ds_read_b64_tr_b16 v[56:57], v3 offset:6144
    ds_read_b64_tr_b16 v[58:59], v3 offset:7680
    v_cvt_pk_bf16_f32 v97, v250, v251
    v_mfma_f32_32x32x16_bf16 v[24:39], v[60:63], v[12:15], v[24:39]
    ds_read_b64_tr_b16 v[60:61], v3 offset:6208
    ds_read_b64_tr_b16 v[62:63], v3 offset:7744
    s_waitcnt lgkmcnt(6)
    v_mfma_f32_32x32x16_bf16 v[40:55], v[64:67], v[12:15], v[40:55]
    ds_read_b64_tr_b16 v[64:65], v3 offset:6272
    ds_read_b64_tr_b16 v[66:67], v3 offset:7808
    s_waitcnt lgkmcnt(6)
    v_mfma_f32_32x32x16_bf16 v[160:175], v[68:71], v[12:15], v[160:175]
    ds_read_b64_tr_b16 v[68:69], v3 offset:9216
    ds_read_b64_tr_b16 v[70:71], v3 offset:10752
    s_waitcnt lgkmcnt(6)
    v_mfma_f32_32x32x16_bf16 v[24:39], v[56:59], v[16:19], v[24:39]
    ds_read_b64_tr_b16 v[56:57], v3 offset:9280
    ds_read_b64_tr_b16 v[58:59], v3 offset:10816
    s_waitcnt lgkmcnt(6)
    v_mfma_f32_32x32x16_bf16 v[40:55], v[60:63], v[16:19], v[40:55]
    ds_read_b64_tr_b16 v[60:61], v3 offset:9344
    ds_read_b64_tr_b16 v[62:63], v3 offset:10880
    s_waitcnt lgkmcnt(6)
    v_mfma_f32_32x32x16_bf16 v[160:175], v[64:67], v[16:19], v[160:175]
    ds_read_b64_tr_b16 v[64:65], v3 offset:12288
    ds_read_b64_tr_b16 v[66:67], v3 offset:13824
    s_waitcnt lgkmcnt(6)
    v_mfma_f32_32x32x16_bf16 v[24:39], v[68:71], v[86:89], v[24:39]
    ds_read_b64_tr_b16 v[68:69], v3 offset:15360
    ds_read_b64_tr_b16 v[70:71], v3 offset:16896
    s_waitcnt lgkmcnt(6)
    v_mfma_f32_32x32x16_bf16 v[40:55], v[56:59], v[86:89], v[40:55]
    ds_read_b64_tr_b16 v[56:57], v3 offset:12352
    ds_read_b64_tr_b16 v[58:59], v3 offset:13888
    s_waitcnt lgkmcnt(6)
    v_mfma_f32_32x32x16_bf16 v[160:175], v[60:63], v[86:89], v[160:175]
    ds_read_b64_tr_b16 v[60:61], v3 offset:15424
    ds_read_b64_tr_b16 v[62:63], v3 offset:16960
    s_waitcnt lgkmcnt(6)
    v_mfma_f32_32x32x16_bf16 v[24:39], v[64:67], v[90:93], v[24:39]
    ds_read_b64_tr_b16 v[64:65], v3 offset:12416
    ds_read_b64_tr_b16 v[66:67], v3 offset:13952
    s_waitcnt lgkmcnt(6)
    v_mfma_f32_32x32x16_bf16 v[24:39], v[68:71], v[94:97], v[24:39]
    ds_read_b64_tr_b16 v[68:69], v3 offset:15488
    ds_read_b64_tr_b16 v[70:71], v3 offset:17024
    s_waitcnt lgkmcnt(6)
    v_mfma_f32_32x32x16_bf16 v[40:55], v[56:59], v[90:93], v[40:55]
    s_nop 7
    v_cvt_pk_bf16_f32 v24, v24, v25
    s_waitcnt lgkmcnt(4)
    v_mfma_f32_32x32x16_bf16 v[40:55], v[60:63], v[94:97], v[40:55]
    v_cvt_pk_bf16_f32 v25, v26, v27
    v_cvt_pk_bf16_f32 v26, v28, v29
    v_cvt_pk_bf16_f32 v27, v30, v31
    v_cvt_pk_bf16_f32 v28, v32, v33
    v_cvt_pk_bf16_f32 v29, v34, v35
    v_cvt_pk_bf16_f32 v30, v36, v37
    v_cvt_pk_bf16_f32 v31, v38, v39
    v_permlane16_swap_b32 v24, v28
    v_permlane16_swap_b32 v25, v29
    s_waitcnt lgkmcnt(2)
    v_mfma_f32_32x32x16_bf16 v[160:175], v[64:67], v[90:93], v[160:175]
    s_setprio 0
    v_cvt_pk_bf16_f32 v40, v40, v41
    v_cvt_pk_bf16_f32 v41, v42, v43
    v_cvt_pk_bf16_f32 v42, v44, v45
    v_cvt_pk_bf16_f32 v43, v46, v47
    v_cvt_pk_bf16_f32 v44, v48, v49
    s_setprio 2
    s_waitcnt lgkmcnt(0)
    v_mfma_f32_32x32x16_bf16 v[160:175], v[68:71], v[94:97], v[160:175]
    s_setprio 0
    v_cvt_pk_bf16_f32 v45, v50, v51
    v_cvt_pk_bf16_f32 v46, v52, v53
    v_cvt_pk_bf16_f32 v47, v54, v55
    v_permlane16_swap_b32 v26, v30
    v_permlane16_swap_b32 v27, v31
    v_permlane16_swap_b32 v40, v44
    v_permlane16_swap_b32 v41, v45
    s_nop 3
    v_cvt_pk_bf16_f32 v160, v160, v161
    v_cvt_pk_bf16_f32 v161, v162, v163
    v_cvt_pk_bf16_f32 v162, v164, v165
    v_cvt_pk_bf16_f32 v163, v166, v167
    v_cvt_pk_bf16_f32 v164, v168, v169
    v_cvt_pk_bf16_f32 v165, v170, v171
    v_cvt_pk_bf16_f32 v166, v172, v173
    v_cvt_pk_bf16_f32 v167, v174, v175
    v_permlane16_swap_b32 v42, v46
    v_permlane16_swap_b32 v43, v47
    v_permlane16_swap_b32 v160, v164
    v_permlane16_swap_b32 v161, v165
    v_permlane16_swap_b32 v162, v166
    v_permlane16_swap_b32 v163, v167
    buffer_store_dwordx4 v[24:27], v0, s[44:47], 0 offen sc1
    buffer_store_dwordx4 v[28:31], v22, s[44:47], 0 offen sc1
    buffer_store_dwordx4 v[40:43], v0, s[44:47], 0 offen offset:64 sc1
    buffer_store_dwordx4 v[44:47], v22, s[44:47], 0 offen offset:64 sc1
    buffer_store_dwordx4 v[160:163], v0, s[44:47], 0 offen offset:128 sc1
    buffer_store_dwordx4 v[164:167], v22, s[44:47], 0 offen offset:128 sc1
    s_endpgm
L_wait0:
    s_sleep 1
    ds_read_b32 v21, v141
    ds_read_b128 v[8:11], v20 offset:3072
    ds_read_b128 v[12:15], v20 offset:4096
    ds_read_b128 v[16:19], v20 offset:5120
    s_waitcnt lgkmcnt(0)
    v_cmp_gt_u32 vcc, 7, v21
    v_cmp_gt_u32 s[74:75], 6, v21
    s_nop 1
    s_and_b32 s70, vcc_lo, s63
    s_or_b32 s70, s70, s74
    s_cbranch_scc1 L_wait0
    s_branch L_back0
L_w10:
    s_sleep 1
    ds_read_b32 v158, v141
    s_waitcnt lgkmcnt(0)
    v_cmp_gt_u32 vcc, 2, v158
    s_nop 1
    s_cbranch_vccnz L_w10
    s_branch L_b10
L_w20:
    s_sleep 1
    ds_read_b32 v158, v141
    s_waitcnt lgkmcnt(0)
    v_cmp_gt_u32 vcc, 3, v158
    s_nop 1
    s_cbranch_vccnz L_w20
    s_branch L_b20
L_w30:
    s_sleep 1
    ds_read_b32 v158, v141
    s_waitcnt lgkmcnt(0)
    v_cmp_gt_u32 vcc, 4, v158
    s_nop 1
    s_cbranch_vccnz L_w30
    s_branch L_b30
L_r001:
    s_waitcnt lgkmcnt(0)
    s_nop 15
    ds_read_b128 v[224:227], v5
    ds_read_b128 v[228:231], v5 offset:128
    ds_read_b128 v[232:235], v5 offset:256
    ds_read_b96 v[236:238], v5 offset:16
    ds_read_b32 v239, v142 offset:384
    ds_read_b96 v[240:242], v5 offset:144
    ds_read_b32 v243, v142 offset:392
    ds_read_b96 v[244:246], v5 offset:272
    ds_read_b32 v247, v142 offset:400
    ds_read_b32 v248, v159 offset:408
    s_waitcnt lgkmcnt(5)
    v_mfma_f32_32x32x16_bf16 v[224:239], v[100:103], v[86:89], v[224:239]
    v_mfma_f32_32x32x16_bf16 v[224:239], v[104:107], v[90:93], v[224:239]
    s_waitcnt lgkmcnt(0)
    v_mfma_f32_32x32x16_bf16 v[240:255], v[114:117], v[86:89], v[240:255]
    v_mfma_f32_32x32x16_bf16 v[240:255], v[118:121], v[90:93], v[240:255]
    s_nop 11
    v_max3_f32 v249, v224, v225, v226
    v_max3_f32 v250, v227, v228, v229
    v_max3_f32 v251, v230, v231, v232
    v_max3_f32 v252, v233, v234, v235
    v_max3_f32 v249, v249, v236, v237
    v_max3_f32 v250, v250, v238, v239
    v_max3_f32 v251, v251, v240, v241
    v_max3_f32 v252, v252, v242, v243
    v_max3_f32 v249, v249, v244, v245
    v_max3_f32 v250, v250, v246, v247
    v_max3_f32 v251, v251, v252, v248
    v_max3_f32 v249, v249, v250, v251
    v_mov_b32 v250, v249
    s_nop 1
    v_permlane32_swap_b32 v249, v250
    v_max_f32 v249, v249, v250
    v_sub_f32 v224, v224, v249
    v_exp_f32 v224, v224
    v_sub_f32 v225, v225, v249
    v_exp_f32 v225, v225
    v_sub_f32 v226, v226, v249
    v_exp_f32 v226, v226
    v_sub_f32 v227, v227, v249
    v_exp_f32 v227, v227
    v_sub_f32 v228, v228, v249
    v_exp_f32 v228, v228
    v_sub_f32 v229, v229, v249
    v_exp_f32 v229, v229
    v_sub_f32 v230, v230, v249
    v_exp_f32 v230, v230
    v_sub_f32 v231, v231, v249
    v_exp_f32 v231, v231
    v_sub_f32 v232, v232, v249
    v_exp_f32 v232, v232
    v_sub_f32 v233, v233, v249
    v_exp_f32 v233, v233
    v_sub_f32 v234, v234, v249
    v_exp_f32 v234, v234
    v_sub_f32 v235, v235, v249
    v_exp_f32 v235, v235
    v_sub_f32 v236, v236, v249
    v_exp_f32 v236, v236
    v_sub_f32 v237, v237, v249
    v_exp_f32 v237, v237
    v_sub_f32 v238, v238, v249
    v_exp_f32 v238, v238
    v_sub_f32 v239, v239, v249
    v_exp_f32 v239, v239
    v_sub_f32 v240, v240, v249
    v_exp_f32 v240, v240
    v_sub_f32 v241, v241, v249
    v_exp_f32 v241, v241
    v_sub_f32 v242, v242, v249
    v_exp_f32 v242, v242
    v_sub_f32 v243, v243, v249
    v_exp_f32 v243, v243
    v_sub_f32 v244, v244, v249
    v_exp_f32 v244, v244
    v_sub_f32 v245, v245, v249
    v_exp_f32 v245, v245
    v_sub_f32 v246, v246, v249
    v_exp_f32 v246, v246
    v_sub_f32 v247, v247, v249
    v_exp_f32 v247, v247
    v_sub_f32 v248, v248, v249
    v_exp_f32 v248, v248
    v_cvt_pk_bf16_f32 v224, v224, v225
    v_cvt_pk_bf16_f32 v225, v226, v227
    v_cvt_pk_bf16_f32 v226, v228, v229
    v_cvt_pk_bf16_f32 v227, v230, v231
    v_cvt_pk_bf16_f32 v228, v232, v233
    v_cvt_pk_bf16_f32 v229, v234, v235
    v_cvt_pk_bf16_f32 v230, v236, v237
    v_cvt_pk_bf16_f32 v231, v238, v239
    v_cvt_pk_bf16_f32 v232, v240, v241
    v_cvt_pk_bf16_f32 v233, v242, v243
    v_cvt_pk_bf16_f32 v234, v244, v245
    v_cvt_pk_bf16_f32 v235, v246, v247
    v_cvt_pk_bf16_f32 v236, v248, 0
    v_mov_b32 v237, 0
    v_mfma_f32_32x32x16_bf16 v[240:255], v[128:131], v[224:227], 0
    v_mfma_f32_32x32x16_bf16 v[240:255], v[132:135], v[228:231], v[240:255]
    v_mfma_f32_32x32x16_bf16 v[240:255], v[136:139], v[232:235], v[240:255]
    v_mfma_f32_32x32x8bf16_1k v[240:255], v[140:141], v[236:237], v[240:255]
    s_nop 11
    v_rcp_f32 v253, v252
    s_nop 0
    v_mul_f32 v240, v253, v240
    v_mul_f32 v241, v253, v241
    s_nop 4
    s_branch L_q001
L_r011:
    s_waitcnt lgkmcnt(0)
    s_nop 15
    ds_read_b128 v[160:163], v5 offset:3392
    ds_read_b128 v[164:167], v5 offset:3520
    ds_read_b128 v[168:171], v5 offset:3648
    ds_read_b96 v[172:174], v5 offset:3408
    ds_read_b32 v175, v142 offset:3776
    ds_read_b96 v[176:178], v5 offset:3536
    ds_read_b32 v179, v142 offset:3784
    ds_read_b96 v[180:182], v5 offset:3664
    ds_read_b32 v183, v142 offset:3792
    ds_read_b32 v184, v159 offset:3800
    s_waitcnt lgkmcnt(5)
    v_mfma_f32_32x32x16_bf16 v[160:175], v[106:109], v[92:95], v[160:175]
    v_mfma_f32_32x32x16_bf16 v[160:175], v[110:113], v[96:99], v[160:175]
    s_waitcnt lgkmcnt(0)
    v_mfma_f32_32x32x16_bf16 v[176:191], v[120:123], v[92:95], v[176:191]
    v_mfma_f32_32x32x16_bf16 v[176:191], v[124:127], v[96:99], v[176:191]
    s_nop 11
    v_max3_f32 v185, v160, v161, v162
    v_max3_f32 v186, v163, v164, v165
    v_max3_f32 v187, v166, v167, v168
    v_max3_f32 v188, v169, v170, v171
    v_max3_f32 v185, v185, v172, v173
    v_max3_f32 v186, v186, v174, v175
    v_max3_f32 v187, v187, v176, v177
    v_max3_f32 v188, v188, v178, v179
    v_max3_f32 v185, v185, v180, v181
    v_max3_f32 v186, v186, v182, v183
    v_max3_f32 v187, v187, v188, v184
    v_max3_f32 v185, v185, v186, v187
    v_mov_b32 v186, v185
    s_nop 1
    v_permlane32_swap_b32 v185, v186
    v_max_f32 v185, v185, v186
    v_sub_f32 v160, v160, v185
    v_exp_f32 v160, v160
    v_sub_f32 v161, v161, v185
    v_exp_f32 v161, v161
    v_sub_f32 v162, v162, v185
    v_exp_f32 v162, v162
    v_sub_f32 v163, v163, v185
    v_exp_f32 v163, v163
    v_sub_f32 v164, v164, v185
    v_exp_f32 v164, v164
    v_sub_f32 v165, v165, v185
    v_exp_f32 v165, v165
    v_sub_f32 v166, v166, v185
    v_exp_f32 v166, v166
    v_sub_f32 v167, v167, v185
    v_exp_f32 v167, v167
    v_sub_f32 v168, v168, v185
    v_exp_f32 v168, v168
    v_sub_f32 v169, v169, v185
    v_exp_f32 v169, v169
    v_sub_f32 v170, v170, v185
    v_exp_f32 v170, v170
    v_sub_f32 v171, v171, v185
    v_exp_f32 v171, v171
    v_sub_f32 v172, v172, v185
    v_exp_f32 v172, v172
    v_sub_f32 v173, v173, v185
    v_exp_f32 v173, v173
    v_sub_f32 v174, v174, v185
    v_exp_f32 v174, v174
    v_sub_f32 v175, v175, v185
    v_exp_f32 v175, v175
    v_sub_f32 v176, v176, v185
    v_exp_f32 v176, v176
    v_sub_f32 v177, v177, v185
    v_exp_f32 v177, v177
    v_sub_f32 v178, v178, v185
    v_exp_f32 v178, v178
    v_sub_f32 v179, v179, v185
    v_exp_f32 v179, v179
    v_sub_f32 v180, v180, v185
    v_exp_f32 v180, v180
    v_sub_f32 v181, v181, v185
    v_exp_f32 v181, v181
    v_sub_f32 v182, v182, v185
    v_exp_f32 v182, v182
    v_sub_f32 v183, v183, v185
    v_exp_f32 v183, v183
    v_sub_f32 v184, v184, v185
    v_exp_f32 v184, v184
    v_cvt_pk_bf16_f32 v160, v160, v161
    v_cvt_pk_bf16_f32 v161, v162, v163
    v_cvt_pk_bf16_f32 v162, v164, v165
    v_cvt_pk_bf16_f32 v163, v166, v167
    v_cvt_pk_bf16_f32 v164, v168, v169
    v_cvt_pk_bf16_f32 v165, v170, v171
    v_cvt_pk_bf16_f32 v166, v172, v173
    v_cvt_pk_bf16_f32 v167, v174, v175
    v_cvt_pk_bf16_f32 v168, v176, v177
    v_cvt_pk_bf16_f32 v169, v178, v179
    v_cvt_pk_bf16_f32 v170, v180, v181
    v_cvt_pk_bf16_f32 v171, v182, v183
    v_cvt_pk_bf16_f32 v172, v184, 0
    v_mov_b32 v173, 0
    v_mfma_f32_32x32x16_bf16 v[176:191], v[144:147], v[160:163], 0
    v_mfma_f32_32x32x16_bf16 v[176:191], v[148:151], v[164:167], v[176:191]
    v_mfma_f32_32x32x16_bf16 v[176:191], v[152:155], v[168:171], v[176:191]
    v_mfma_f32_32x32x8bf16_1k v[176:191], v[156:157], v[172:173], v[176:191]
    s_nop 11
    v_rcp_f32 v189, v188
    s_nop 0
    v_mul_f32 v176, v189, v176
    v_mul_f32 v177, v189, v177
    s_nop 4
    s_branch L_q011
L_r000:
    s_waitcnt lgkmcnt(0)
    s_nop 15
    ds_read_b128 v[192:195], v4
    ds_read_b128 v[196:199], v4 offset:128
    ds_read_b128 v[200:203], v4 offset:256
    ds_read_b96 v[204:206], v4 offset:16
    ds_read_b32 v207, v6 offset:384
    ds_read_b96 v[208:210], v4 offset:144
    ds_read_b32 v211, v6 offset:392
    ds_read_b96 v[212:214], v4 offset:272
    ds_read_b32 v215, v6 offset:400
    ds_read_b32 v216, v143 offset:408
    s_waitcnt lgkmcnt(5)
    v_mfma_f32_32x32x16_bf16 v[192:207], v[100:103], v[72:75], v[192:207]
    v_mfma_f32_32x32x16_bf16 v[192:207], v[104:107], v[76:79], v[192:207]
    s_waitcnt lgkmcnt(0)
    v_mfma_f32_32x32x16_bf16 v[208:223], v[114:117], v[72:75], v[208:223]
    v_mfma_f32_32x32x16_bf16 v[208:223], v[118:121], v[76:79], v[208:223]
    s_nop 11
    v_max3_f32 v217, v192, v193, v194
    v_max3_f32 v218, v195, v196, v197
    v_max3_f32 v219, v198, v199, v200
    v_max3_f32 v220, v201, v202, v203
    v_max3_f32 v217, v217, v204, v205
    v_max3_f32 v218, v218, v206, v207
    v_max3_f32 v219, v219, v208, v209
    v_max3_f32 v220, v220, v210, v211
    v_max3_f32 v217, v217, v212, v213
    v_max3_f32 v218, v218, v214, v215
    v_max3_f32 v219, v219, v220, v216
    v_max3_f32 v217, v217, v218, v219
    v_mov_b32 v218, v217
    s_nop 1
    v_permlane32_swap_b32 v217, v218
    v_max_f32 v217, v217, v218
    v_sub_f32 v192, v192, v217
    v_exp_f32 v192, v192
    v_sub_f32 v193, v193, v217
    v_exp_f32 v193, v193
    v_sub_f32 v194, v194, v217
    v_exp_f32 v194, v194
    v_sub_f32 v195, v195, v217
    v_exp_f32 v195, v195
    v_sub_f32 v196, v196, v217
    v_exp_f32 v196, v196
    v_sub_f32 v197, v197, v217
    v_exp_f32 v197, v197
    v_sub_f32 v198, v198, v217
    v_exp_f32 v198, v198
    v_sub_f32 v199, v199, v217
    v_exp_f32 v199, v199
    v_sub_f32 v200, v200, v217
    v_exp_f32 v200, v200
    v_sub_f32 v201, v201, v217
    v_exp_f32 v201, v201
    v_sub_f32 v202, v202, v217
    v_exp_f32 v202, v202
    v_sub_f32 v203, v203, v217
    v_exp_f32 v203, v203
    v_sub_f32 v204, v204, v217
    v_exp_f32 v204, v204
    v_sub_f32 v205, v205, v217
    v_exp_f32 v205, v205
    v_sub_f32 v206, v206, v217
    v_exp_f32 v206, v206
    v_sub_f32 v207, v207, v217
    v_exp_f32 v207, v207
    v_sub_f32 v208, v208, v217
    v_exp_f32 v208, v208
    v_sub_f32 v209, v209, v217
    v_exp_f32 v209, v209
    v_sub_f32 v210, v210, v217
    v_exp_f32 v210, v210
    v_sub_f32 v211, v211, v217
    v_exp_f32 v211, v211
    v_sub_f32 v212, v212, v217
    v_exp_f32 v212, v212
    v_sub_f32 v213, v213, v217
    v_exp_f32 v213, v213
    v_sub_f32 v214, v214, v217
    v_exp_f32 v214, v214
    v_sub_f32 v215, v215, v217
    v_exp_f32 v215, v215
    v_sub_f32 v216, v216, v217
    v_exp_f32 v216, v216
    v_cvt_pk_bf16_f32 v192, v192, v193
    v_cvt_pk_bf16_f32 v193, v194, v195
    v_cvt_pk_bf16_f32 v194, v196, v197
    v_cvt_pk_bf16_f32 v195, v198, v199
    v_cvt_pk_bf16_f32 v196, v200, v201
    v_cvt_pk_bf16_f32 v197, v202, v203
    v_cvt_pk_bf16_f32 v198, v204, v205
    v_cvt_pk_bf16_f32 v199, v206, v207
    v_cvt_pk_bf16_f32 v200, v208, v209
    v_cvt_pk_bf16_f32 v201, v210, v211
    v_cvt_pk_bf16_f32 v202, v212, v213
    v_cvt_pk_bf16_f32 v203, v214, v215
    v_cvt_pk_bf16_f32 v204, v216, 0
    v_mov_b32 v205, 0
    v_mfma_f32_32x32x16_bf16 v[208:223], v[128:131], v[192:195], 0
    v_mfma_f32_32x32x16_bf16 v[208:223], v[132:135], v[196:199], v[208:223]
    v_mfma_f32_32x32x16_bf16 v[208:223], v[136:139], v[200:203], v[208:223]
    v_mfma_f32_32x32x8bf16_1k v[208:223], v[140:141], v[204:205], v[208:223]
    s_nop 11
    v_rcp_f32 v221, v220
    s_nop 0
    v_mul_f32 v208, v221, v208
    v_mul_f32 v209, v221, v209
    s_nop 4
    s_branch L_q000
L_r010:
    s_waitcnt lgkmcnt(0)
    s_nop 15
    ds_read_b128 v[224:227], v4 offset:3392
    ds_read_b128 v[228:231], v4 offset:3520
    ds_read_b128 v[232:235], v4 offset:3648
    ds_read_b96 v[236:238], v4 offset:3408
    ds_read_b32 v239, v6 offset:3776
    ds_read_b96 v[240:242], v4 offset:3536
    ds_read_b32 v243, v6 offset:3784
    ds_read_b96 v[244:246], v4 offset:3664
    ds_read_b32 v247, v6 offset:3792
    ds_read_b32 v248, v143 offset:3800
    s_waitcnt lgkmcnt(5)
    v_mfma_f32_32x32x16_bf16 v[224:239], v[106:109], v[78:81], v[224:239]
    v_mfma_f32_32x32x16_bf16 v[224:239], v[110:113], v[82:85], v[224:239]
    s_waitcnt lgkmcnt(0)
    v_mfma_f32_32x32x16_bf16 v[240:255], v[120:123], v[78:81], v[240:255]
    v_mfma_f32_32x32x16_bf16 v[240:255], v[124:127], v[82:85], v[240:255]
    s_nop 11
    v_max3_f32 v249, v224, v225, v226
    v_max3_f32 v250, v227, v228, v229
    v_max3_f32 v251, v230, v231, v232
    v_max3_f32 v252, v233, v234, v235
    v_max3_f32 v249, v249, v236, v237
    v_max3_f32 v250, v250, v238, v239
    v_max3_f32 v251, v251, v240, v241
    v_max3_f32 v252, v252, v242, v243
    v_max3_f32 v249, v249, v244, v245
    v_max3_f32 v250, v250, v246, v247
    v_max3_f32 v251, v251, v252, v248
    v_max3_f32 v249, v249, v250, v251
    v_mov_b32 v250, v249
    s_nop 1
    v_permlane32_swap_b32 v249, v250
    v_max_f32 v249, v249, v250
    v_sub_f32 v224, v224, v249
    v_exp_f32 v224, v224
    v_sub_f32 v225, v225, v249
    v_exp_f32 v225, v225
    v_sub_f32 v226, v226, v249
    v_exp_f32 v226, v226
    v_sub_f32 v227, v227, v249
    v_exp_f32 v227, v227
    v_sub_f32 v228, v228, v249
    v_exp_f32 v228, v228
    v_sub_f32 v229, v229, v249
    v_exp_f32 v229, v229
    v_sub_f32 v230, v230, v249
    v_exp_f32 v230, v230
    v_sub_f32 v231, v231, v249
    v_exp_f32 v231, v231
    v_sub_f32 v232, v232, v249
    v_exp_f32 v232, v232
    v_sub_f32 v233, v233, v249
    v_exp_f32 v233, v233
    v_sub_f32 v234, v234, v249
    v_exp_f32 v234, v234
    v_sub_f32 v235, v235, v249
    v_exp_f32 v235, v235
    v_sub_f32 v236, v236, v249
    v_exp_f32 v236, v236
    v_sub_f32 v237, v237, v249
    v_exp_f32 v237, v237
    v_sub_f32 v238, v238, v249
    v_exp_f32 v238, v238
    v_sub_f32 v239, v239, v249
    v_exp_f32 v239, v239
    v_sub_f32 v240, v240, v249
    v_exp_f32 v240, v240
    v_sub_f32 v241, v241, v249
    v_exp_f32 v241, v241
    v_sub_f32 v242, v242, v249
    v_exp_f32 v242, v242
    v_sub_f32 v243, v243, v249
    v_exp_f32 v243, v243
    v_sub_f32 v244, v244, v249
    v_exp_f32 v244, v244
    v_sub_f32 v245, v245, v249
    v_exp_f32 v245, v245
    v_sub_f32 v246, v246, v249
    v_exp_f32 v246, v246
    v_sub_f32 v247, v247, v249
    v_exp_f32 v247, v247
    v_sub_f32 v248, v248, v249
    v_exp_f32 v248, v248
    v_cvt_pk_bf16_f32 v224, v224, v225
    v_cvt_pk_bf16_f32 v225, v226, v227
    v_cvt_pk_bf16_f32 v226, v228, v229
    v_cvt_pk_bf16_f32 v227, v230, v231
    v_cvt_pk_bf16_f32 v228, v232, v233
    v_cvt_pk_bf16_f32 v229, v234, v235
    v_cvt_pk_bf16_f32 v230, v236, v237
    v_cvt_pk_bf16_f32 v231, v238, v239
    v_cvt_pk_bf16_f32 v232, v240, v241
    v_cvt_pk_bf16_f32 v233, v242, v243
    v_cvt_pk_bf16_f32 v234, v244, v245
    v_cvt_pk_bf16_f32 v235, v246, v247
    v_cvt_pk_bf16_f32 v236, v248, 0
    v_mov_b32 v237, 0
    v_mfma_f32_32x32x16_bf16 v[240:255], v[144:147], v[224:227], 0
    v_mfma_f32_32x32x16_bf16 v[240:255], v[148:151], v[228:231], v[240:255]
    v_mfma_f32_32x32x16_bf16 v[240:255], v[152:155], v[232:235], v[240:255]
    v_mfma_f32_32x32x8bf16_1k v[240:255], v[156:157], v[236:237], v[240:255]
    s_nop 11
    v_rcp_f32 v253, v252
    s_nop 0
    v_mul_f32 v240, v253, v240
    v_mul_f32 v241, v253, v241
    s_nop 4
    s_branch L_q010
L_wait1:
    s_sleep 1
    ds_read_b32 v21, v141
    ds_read_b128 v[8:11], v20
    ds_read_b128 v[12:15], v20 offset:1024
    ds_read_b128 v[16:19], v20 offset:2048
    s_waitcnt lgkmcnt(0)
    v_cmp_gt_u32 vcc, 7, v21
    v_cmp_gt_u32 s[74:75], 6, v21
    s_nop 1
    s_and_b32 s70, vcc_lo, s63
    s_or_b32 s70, s70, s74
    s_cbranch_scc1 L_wait1
    s_branch L_back1
L_w11:
    s_sleep 1
    ds_read_b32 v158, v141
    s_waitcnt lgkmcnt(0)
    v_cmp_gt_u32 vcc, 2, v158
    s_nop 1
    s_cbranch_vccnz L_w11
    s_branch L_b11
L_w21:
    s_sleep 1
    ds_read_b32 v158, v141
    s_waitcnt lgkmcnt(0)
    v_cmp_gt_u32 vcc, 3, v158
    s_nop 1
    s_cbranch_vccnz L_w21
    s_branch L_b21
L_w31:
    s_sleep 1
    ds_read_b32 v158, v141
    s_waitcnt lgkmcnt(0)
    v_cmp_gt_u32 vcc, 4, v158
    s_nop 1
    s_cbranch_vccnz L_w31
    s_branch L_b31
L_r100:
    s_waitcnt lgkmcnt(0)
    s_nop 15
    ds_read_b128 v[224:227], v4
    ds_read_b128 v[228:231], v4 offset:128
    ds_read_b128 v[232:235], v4 offset:256
    ds_read_b96 v[236:238], v4 offset:16
    ds_read_b32 v239, v6 offset:384
    ds_read_b96 v[240:242], v4 offset:144
    ds_read_b32 v243, v6 offset:392
    ds_read_b96 v[244:246], v4 offset:272
    ds_read_b32 v247, v6 offset:400
    ds_read_b32 v248, v143 offset:408
    s_waitcnt lgkmcnt(5)
    v_mfma_f32_32x32x16_bf16 v[224:239], v[100:103], v[72:75], v[224:239]
    v_mfma_f32_32x32x16_bf16 v[224:239], v[104:107], v[76:79], v[224:239]
    s_waitcnt lgkmcnt(0)
    v_mfma_f32_32x32x16_bf16 v[240:255], v[114:117], v[72:75], v[240:255]
    v_mfma_f32_32x32x16_bf16 v[240:255], v[118:121], v[76:79], v[240:255]
    s_nop 11
    v_max3_f32 v249, v224, v225, v226
    v_max3_f32 v250, v227, v228, v229
    v_max3_f32 v251, v230, v231, v232
    v_max3_f32 v252, v233, v234, v235
    v_max3_f32 v249, v249, v236, v237
    v_max3_f32 v250, v250, v238, v239
    v_max3_f32 v251, v251, v240, v241
    v_max3_f32 v252, v252, v242, v243
    v_max3_f32 v249, v249, v244, v245
    v_max3_f32 v250, v250, v246, v247
    v_max3_f32 v251, v251, v252, v248
    v_max3_f32 v249, v249, v250, v251
    v_mov_b32 v250, v249
    s_nop 1
    v_permlane32_swap_b32 v249, v250
    v_max_f32 v249, v249, v250
    v_sub_f32 v224, v224, v249
    v_exp_f32 v224, v224
    v_sub_f32 v225, v225, v249
    v_exp_f32 v225, v225
    v_sub_f32 v226, v226, v249
    v_exp_f32 v226, v226
    v_sub_f32 v227, v227, v249
    v_exp_f32 v227, v227
    v_sub_f32 v228, v228, v249
    v_exp_f32 v228, v228
    v_sub_f32 v229, v229, v249
    v_exp_f32 v229, v229
    v_sub_f32 v230, v230, v249
    v_exp_f32 v230, v230
    v_sub_f32 v231, v231, v249
    v_exp_f32 v231, v231
    v_sub_f32 v232, v232, v249
    v_exp_f32 v232, v232
    v_sub_f32 v233, v233, v249
    v_exp_f32 v233, v233
    v_sub_f32 v234, v234, v249
    v_exp_f32 v234, v234
    v_sub_f32 v235, v235, v249
    v_exp_f32 v235, v235
    v_sub_f32 v236, v236, v249
    v_exp_f32 v236, v236
    v_sub_f32 v237, v237, v249
    v_exp_f32 v237, v237
    v_sub_f32 v238, v238, v249
    v_exp_f32 v238, v238
    v_sub_f32 v239, v239, v249
    v_exp_f32 v239, v239
    v_sub_f32 v240, v240, v249
    v_exp_f32 v240, v240
    v_sub_f32 v241, v241, v249
    v_exp_f32 v241, v241
    v_sub_f32 v242, v242, v249
    v_exp_f32 v242, v242
    v_sub_f32 v243, v243, v249
    v_exp_f32 v243, v243
    v_sub_f32 v244, v244, v249
    v_exp_f32 v244, v244
    v_sub_f32 v245, v245, v249
    v_exp_f32 v245, v245
    v_sub_f32 v246, v246, v249
    v_exp_f32 v246, v246
    v_sub_f32 v247, v247, v249
    v_exp_f32 v247, v247
    v_sub_f32 v248, v248, v249
    v_exp_f32 v248, v248
    v_cvt_pk_bf16_f32 v224, v224, v225
    v_cvt_pk_bf16_f32 v225, v226, v227
    v_cvt_pk_bf16_f32 v226, v228, v229
    v_cvt_pk_bf16_f32 v227, v230, v231
    v_cvt_pk_bf16_f32 v228, v232, v233
    v_cvt_pk_bf16_f32 v229, v234, v235
    v_cvt_pk_bf16_f32 v230, v236, v237
    v_cvt_pk_bf16_f32 v231, v238, v239
    v_cvt_pk_bf16_f32 v232, v240, v241
    v_cvt_pk_bf16_f32 v233, v242, v243
    v_cvt_pk_bf16_f32 v234, v244, v245
    v_cvt_pk_bf16_f32 v235, v246, v247
    v_cvt_pk_bf16_f32 v236, v248, 0
    v_mov_b32 v237, 0
    v_mfma_f32_32x32x16_bf16 v[240:255], v[128:131], v[224:227], 0
    v_mfma_f32_32x32x16_bf16 v[240:255], v[132:135], v[228:231], v[240:255]
    v_mfma_f32_32x32x16_bf16 v[240:255], v[136:139], v[232:235], v[240:255]
    v_mfma_f32_32x32x8bf16_1k v[240:255], v[140:141], v[236:237], v[240:255]
    s_nop 11
    v_rcp_f32 v253, v252
    s_nop 0
    v_mul_f32 v240, v253, v240
    v_mul_f32 v241, v253, v241
    s_nop 4
    s_branch L_q100
L_r110:
    s_waitcnt lgkmcnt(0)
    s_nop 15
    ds_read_b128 v[160:163], v4 offset:3392
    ds_read_b128 v[164:167], v4 offset:3520
    ds_read_b128 v[168:171], v4 offset:3648
    ds_read_b96 v[172:174], v4 offset:3408
    ds_read_b32 v175, v6 offset:3776
    ds_read_b96 v[176:178], v4 offset:3536
    ds_read_b32 v179, v6 offset:3784
    ds_read_b96 v[180:182], v4 offset:3664
    ds_read_b32 v183, v6 offset:3792
    ds_read_b32 v184, v143 offset:3800
    s_waitcnt lgkmcnt(5)
    v_mfma_f32_32x32x16_bf16 v[160:175], v[106:109], v[78:81], v[160:175]
    v_mfma_f32_32x32x16_bf16 v[160:175], v[110:113], v[82:85], v[160:175]
    s_waitcnt lgkmcnt(0)
    v_mfma_f32_32x32x16_bf16 v[176:191], v[120:123], v[78:81], v[176:191]
    v_mfma_f32_32x32x16_bf16 v[176:191], v[124:127], v[82:85], v[176:191]
    s_nop 11
    v_max3_f32 v185, v160, v161, v162
    v_max3_f32 v186, v163, v164, v165
    v_max3_f32 v187, v166, v167, v168
    v_max3_f32 v188, v169, v170, v171
    v_max3_f32 v185, v185, v172, v173
    v_max3_f32 v186, v186, v174, v175
    v_max3_f32 v187, v187, v176, v177
    v_max3_f32 v188, v188, v178, v179
    v_max3_f32 v185, v185, v180, v181
    v_max3_f32 v186, v186, v182, v183
    v_max3_f32 v187, v187, v188, v184
    v_max3_f32 v185, v185, v186, v187
    v_mov_b32 v186, v185
    s_nop 1
    v_permlane32_swap_b32 v185, v186
    v_max_f32 v185, v185, v186
    v_sub_f32 v160, v160, v185
    v_exp_f32 v160, v160
    v_sub_f32 v161, v161, v185
    v_exp_f32 v161, v161
    v_sub_f32 v162, v162, v185
    v_exp_f32 v162, v162
    v_sub_f32 v163, v163, v185
    v_exp_f32 v163, v163
    v_sub_f32 v164, v164, v185
    v_exp_f32 v164, v164
    v_sub_f32 v165, v165, v185
    v_exp_f32 v165, v165
    v_sub_f32 v166, v166, v185
    v_exp_f32 v166, v166
    v_sub_f32 v167, v167, v185
    v_exp_f32 v167, v167
    v_sub_f32 v168, v168, v185
    v_exp_f32 v168, v168
    v_sub_f32 v169, v169, v185
    v_exp_f32 v169, v169
    v_sub_f32 v170, v170, v185
    v_exp_f32 v170, v170
    v_sub_f32 v171, v171, v185
    v_exp_f32 v171, v171
    v_sub_f32 v172, v172, v185
    v_exp_f32 v172, v172
    v_sub_f32 v173, v173, v185
    v_exp_f32 v173, v173
    v_sub_f32 v174, v174, v185
    v_exp_f32 v174, v174
    v_sub_f32 v175, v175, v185
    v_exp_f32 v175, v175
    v_sub_f32 v176, v176, v185
    v_exp_f32 v176, v176
    v_sub_f32 v177, v177, v185
    v_exp_f32 v177, v177
    v_sub_f32 v178, v178, v185
    v_exp_f32 v178, v178
    v_sub_f32 v179, v179, v185
    v_exp_f32 v179, v179
    v_sub_f32 v180, v180, v185
    v_exp_f32 v180, v180
    v_sub_f32 v181, v181, v185
    v_exp_f32 v181, v181
    v_sub_f32 v182, v182, v185
    v_exp_f32 v182, v182
    v_sub_f32 v183, v183, v185
    v_exp_f32 v183, v183
    v_sub_f32 v184, v184, v185
    v_exp_f32 v184, v184
    v_cvt_pk_bf16_f32 v160, v160, v161
    v_cvt_pk_bf16_f32 v161, v162, v163
    v_cvt_pk_bf16_f32 v162, v164, v165
    v_cvt_pk_bf16_f32 v163, v166, v167
    v_cvt_pk_bf16_f32 v164, v168, v169
    v_cvt_pk_bf16_f32 v165, v170, v171
    v_cvt_pk_bf16_f32 v166, v172, v173
    v_cvt_pk_bf16_f32 v167, v174, v175
    v_cvt_pk_bf16_f32 v168, v176, v177
    v_cvt_pk_bf16_f32 v169, v178, v179
    v_cvt_pk_bf16_f32 v170, v180, v181
    v_cvt_pk_bf16_f32 v171, v182, v183
    v_cvt_pk_bf16_f32 v172, v184, 0
    v_mov_b32 v173, 0
    v_mfma_f32_32x32x16_bf16 v[176:191], v[144:147], v[160:163], 0
    v_mfma_f32_32x32x16_bf16 v[176:191], v[148:151], v[164:167], v[176:191]
    v_mfma_f32_32x32x16_bf16 v[176:191], v[152:155], v[168:171], v[176:191]
    v_mfma_f32_32x32x8bf16_1k v[176:191], v[156:157], v[172:173], v[176:191]
    s_nop 11
    v_rcp_f32 v189, v188
    s_nop 0
    v_mul_f32 v176, v189, v176
    v_mul_f32 v177, v189, v177
    s_nop 4
    s_branch L_q110
L_r101:
    s_waitcnt lgkmcnt(0)
    s_nop 15
    ds_read_b128 v[192:195], v5
    ds_read_b128 v[196:199], v5 offset:128
    ds_read_b128 v[200:203], v5 offset:256
    ds_read_b96 v[204:206], v5 offset:16
    ds_read_b32 v207, v142 offset:384
    ds_read_b96 v[208:210], v5 offset:144
    ds_read_b32 v211, v142 offset:392
    ds_read_b96 v[212:214], v5 offset:272
    ds_read_b32 v215, v142 offset:400
    ds_read_b32 v216, v159 offset:408
    s_waitcnt lgkmcnt(5)
    v_mfma_f32_32x32x16_bf16 v[192:207], v[100:103], v[86:89], v[192:207]
    v_mfma_f32_32x32x16_bf16 v[192:207], v[104:107], v[90:93], v[192:207]
    s_waitcnt lgkmcnt(0)
    v_mfma_f32_32x32x16_bf16 v[208:223], v[114:117], v[86:89], v[208:223]
    v_mfma_f32_32x32x16_bf16 v[208:223], v[118:121], v[90:93], v[208:223]
    s_nop 11
    v_max3_f32 v217, v192, v193, v194
    v_max3_f32 v218, v195, v196, v197
    v_max3_f32 v219, v198, v199, v200
    v_max3_f32 v220, v201, v202, v203
    v_max3_f32 v217, v217, v204, v205
    v_max3_f32 v218, v218, v206, v207
    v_max3_f32 v219, v219, v208, v209
    v_max3_f32 v220, v220, v210, v211
    v_max3_f32 v217, v217, v212, v213
    v_max3_f32 v218, v218, v214, v215
    v_max3_f32 v219, v219, v220, v216
    v_max3_f32 v217, v217, v218, v219
    v_mov_b32 v218, v217
    s_nop 1
    v_permlane32_swap_b32 v217, v218
    v_max_f32 v217, v217, v218
    v_sub_f32 v192, v192, v217
    v_exp_f32 v192, v192
    v_sub_f32 v193, v193, v217
    v_exp_f32 v193, v193
    v_sub_f32 v194, v194, v217
    v_exp_f32 v194, v194
    v_sub_f32 v195, v195, v217
    v_exp_f32 v195, v195
    v_sub_f32 v196, v196, v217
    v_exp_f32 v196, v196
    v_sub_f32 v197, v197, v217
    v_exp_f32 v197, v197
    v_sub_f32 v198, v198, v217
    v_exp_f32 v198, v198
    v_sub_f32 v199, v199, v217
    v_exp_f32 v199, v199
    v_sub_f32 v200, v200, v217
    v_exp_f32 v200, v200
    v_sub_f32 v201, v201, v217
    v_exp_f32 v201, v201
    v_sub_f32 v202, v202, v217
    v_exp_f32 v202, v202
    v_sub_f32 v203, v203, v217
    v_exp_f32 v203, v203
    v_sub_f32 v204, v204, v217
    v_exp_f32 v204, v204
    v_sub_f32 v205, v205, v217
    v_exp_f32 v205, v205
    v_sub_f32 v206, v206, v217
    v_exp_f32 v206, v206
    v_sub_f32 v207, v207, v217
    v_exp_f32 v207, v207
    v_sub_f32 v208, v208, v217
    v_exp_f32 v208, v208
    v_sub_f32 v209, v209, v217
    v_exp_f32 v209, v209
    v_sub_f32 v210, v210, v217
    v_exp_f32 v210, v210
    v_sub_f32 v211, v211, v217
    v_exp_f32 v211, v211
    v_sub_f32 v212, v212, v217
    v_exp_f32 v212, v212
    v_sub_f32 v213, v213, v217
    v_exp_f32 v213, v213
    v_sub_f32 v214, v214, v217
    v_exp_f32 v214, v214
    v_sub_f32 v215, v215, v217
    v_exp_f32 v215, v215
    v_sub_f32 v216, v216, v217
    v_exp_f32 v216, v216
    v_cvt_pk_bf16_f32 v192, v192, v193
    v_cvt_pk_bf16_f32 v193, v194, v195
    v_cvt_pk_bf16_f32 v194, v196, v197
    v_cvt_pk_bf16_f32 v195, v198, v199
    v_cvt_pk_bf16_f32 v196, v200, v201
    v_cvt_pk_bf16_f32 v197, v202, v203
    v_cvt_pk_bf16_f32 v198, v204, v205
    v_cvt_pk_bf16_f32 v199, v206, v207
    v_cvt_pk_bf16_f32 v200, v208, v209
    v_cvt_pk_bf16_f32 v201, v210, v211
    v_cvt_pk_bf16_f32 v202, v212, v213
    v_cvt_pk_bf16_f32 v203, v214, v215
    v_cvt_pk_bf16_f32 v204, v216, 0
    v_mov_b32 v205, 0
    v_mfma_f32_32x32x16_bf16 v[208:223], v[128:131], v[192:195], 0
    v_mfma_f32_32x32x16_bf16 v[208:223], v[132:135], v[196:199], v[208:223]
    v_mfma_f32_32x32x16_bf16 v[208:223], v[136:139], v[200:203], v[208:223]
    v_mfma_f32_32x32x8bf16_1k v[208:223], v[140:141], v[204:205], v[208:223]
    s_nop 11
    v_rcp_f32 v221, v220
    s_nop 0
    v_mul_f32 v208, v221, v208
    v_mul_f32 v209, v221, v209
    s_nop 4
    s_branch L_q101
L_r111:
    s_waitcnt lgkmcnt(0)
    s_nop 15
    ds_read_b128 v[224:227], v5 offset:3392
    ds_read_b128 v[228:231], v5 offset:3520
    ds_read_b128 v[232:235], v5 offset:3648
    ds_read_b96 v[236:238], v5 offset:3408
    ds_read_b32 v239, v142 offset:3776
    ds_read_b96 v[240:242], v5 offset:3536
    ds_read_b32 v243, v142 offset:3784
    ds_read_b96 v[244:246], v5 offset:3664
    ds_read_b32 v247, v142 offset:3792
    ds_read_b32 v248, v159 offset:3800
    s_waitcnt lgkmcnt(5)
    v_mfma_f32_32x32x16_bf16 v[224:239], v[106:109], v[92:95], v[224:239]
    v_mfma_f32_32x32x16_bf16 v[224:239], v[110:113], v[96:99], v[224:239]
    s_waitcnt lgkmcnt(0)
    v_mfma_f32_32x32x16_bf16 v[240:255], v[120:123], v[92:95], v[240:255]
    v_mfma_f32_32x32x16_bf16 v[240:255], v[124:127], v[96:99], v[240:255]
    s_nop 11
    v_max3_f32 v249, v224, v225, v226
    v_max3_f32 v250, v227, v228, v229
    v_max3_f32 v251, v230, v231, v232
    v_max3_f32 v252, v233, v234, v235
    v_max3_f32 v249, v249, v236, v237
    v_max3_f32 v250, v250, v238, v239
    v_max3_f32 v251, v251, v240, v241
    v_max3_f32 v252, v252, v242, v243
    v_max3_f32 v249, v249, v244, v245
    v_max3_f32 v250, v250, v246, v247
    v_max3_f32 v251, v251, v252, v248
    v_max3_f32 v249, v249, v250, v251
    v_mov_b32 v250, v249
    s_nop 1
    v_permlane32_swap_b32 v249, v250
    v_max_f32 v249, v249, v250
    v_sub_f32 v224, v224, v249
    v_exp_f32 v224, v224
    v_sub_f32 v225, v225, v249
    v_exp_f32 v225, v225
    v_sub_f32 v226, v226, v249
    v_exp_f32 v226, v226
    v_sub_f32 v227, v227, v249
    v_exp_f32 v227, v227
    v_sub_f32 v228, v228, v249
    v_exp_f32 v228, v228
    v_sub_f32 v229, v229, v249
    v_exp_f32 v229, v229
    v_sub_f32 v230, v230, v249
    v_exp_f32 v230, v230
    v_sub_f32 v231, v231, v249
    v_exp_f32 v231, v231
    v_sub_f32 v232, v232, v249
    v_exp_f32 v232, v232
    v_sub_f32 v233, v233, v249
    v_exp_f32 v233, v233
    v_sub_f32 v234, v234, v249
    v_exp_f32 v234, v234
    v_sub_f32 v235, v235, v249
    v_exp_f32 v235, v235
    v_sub_f32 v236, v236, v249
    v_exp_f32 v236, v236
    v_sub_f32 v237, v237, v249
    v_exp_f32 v237, v237
    v_sub_f32 v238, v238, v249
    v_exp_f32 v238, v238
    v_sub_f32 v239, v239, v249
    v_exp_f32 v239, v239
    v_sub_f32 v240, v240, v249
    v_exp_f32 v240, v240
    v_sub_f32 v241, v241, v249
    v_exp_f32 v241, v241
    v_sub_f32 v242, v242, v249
    v_exp_f32 v242, v242
    v_sub_f32 v243, v243, v249
    v_exp_f32 v243, v243
    v_sub_f32 v244, v244, v249
    v_exp_f32 v244, v244
    v_sub_f32 v245, v245, v249
    v_exp_f32 v245, v245
    v_sub_f32 v246, v246, v249
    v_exp_f32 v246, v246
    v_sub_f32 v247, v247, v249
    v_exp_f32 v247, v247
    v_sub_f32 v248, v248, v249
    v_exp_f32 v248, v248
    v_cvt_pk_bf16_f32 v224, v224, v225
    v_cvt_pk_bf16_f32 v225, v226, v227
    v_cvt_pk_bf16_f32 v226, v228, v229
    v_cvt_pk_bf16_f32 v227, v230, v231
    v_cvt_pk_bf16_f32 v228, v232, v233
    v_cvt_pk_bf16_f32 v229, v234, v235
    v_cvt_pk_bf16_f32 v230, v236, v237
    v_cvt_pk_bf16_f32 v231, v238, v239
    v_cvt_pk_bf16_f32 v232, v240, v241
    v_cvt_pk_bf16_f32 v233, v242, v243
    v_cvt_pk_bf16_f32 v234, v244, v245
    v_cvt_pk_bf16_f32 v235, v246, v247
    v_cvt_pk_bf16_f32 v236, v248, 0
    v_mov_b32 v237, 0
    v_mfma_f32_32x32x16_bf16 v[240:255], v[144:147], v[224:227], 0
    v_mfma_f32_32x32x16_bf16 v[240:255], v[148:151], v[228:231], v[240:255]
    v_mfma_f32_32x32x16_bf16 v[240:255], v[152:155], v[232:235], v[240:255]
    v_mfma_f32_32x32x8bf16_1k v[240:255], v[156:157], v[236:237], v[240:255]
    s_nop 11
    v_rcp_f32 v253, v252
    s_nop 0
    v_mul_f32 v240, v253, v240
    v_mul_f32 v241, v253, v241
    s_nop 4
    s_branch L_q111
L_end:
s_endpgm
.section .rodata,"a"
.p2align 6
.amdhsa_kernel standalone__window_attn_swin__vision_kernel
  .amdhsa_next_free_vgpr 256
  .amdhsa_next_free_sgpr 102
  .amdhsa_accum_offset 256
  .amdhsa_group_segment_fixed_size 0
  .amdhsa_kernarg_size 72
  .amdhsa_user_sgpr_count 2
  .amdhsa_user_sgpr_kernarg_segment_ptr 1
  .amdhsa_system_sgpr_workgroup_id_x 1
.end_amdhsa_kernel
```
